```python
import torch

def _softmax(x, axis=-1):
    return torch.softmax(x, dim=axis)
def _gelu(x):
    return torch.nn.functional.gelu(x, approximate="tanh")
def _silu(x):
    return torch.nn.functional.silu(x)
def _sigmoid(x):
    return torch.sigmoid(x)
def _layernorm(x, axis=-1, eps=1e-5):
    m = x.mean(dim=axis, keepdim=True)
    v = x.var(dim=axis, keepdim=True, unbiased=False)
    return (x - m) / torch.sqrt(v + eps)
def _scatter_add(tgt, idx, src, axis=0):
    return tgt.clone().index_add_(axis, idx, src)
def _segment_sum(src, seg, n):
    out = torch.zeros((n,) + src.shape[1:], dtype=src.dtype)
    return out.index_add_(0, seg, src)
def _pad(x, pw):
    flat = tuple(v for pair in reversed(pw) for v in pair)
    return torch.nn.functional.pad(x, flat)

kernel_name = 'parallel_sum__sliding_block_cached__glu_gated_geglu__decode'

def setup_inputs():

    _w = (lambda a: (lambda t: t.to(torch.bfloat16) if t.is_floating_point() else t)(torch.as_tensor(a)))
    def _A_setup():
        B, Sq, D = 2, 1, 448
        Hq, Hkv, Sk, Dh = 16, 8, 32768, 256
        assert Hq % Hkv == 0, (Hq, Hkv)
        return {
            "x": _w((lambda *s: torch.randn(*s, dtype=torch.bfloat16) * 0.05)(B, Sq, D)),
            "k_cache": _w((lambda *s: torch.randn(*s, dtype=torch.bfloat16) * 1.6)(B, Hkv, Sk, Dh)),
            "v_cache": _w((lambda *s: torch.randn(*s, dtype=torch.bfloat16) * 0.8)(B, Hkv, Sk, Dh)),
            "wq": _w((lambda *s: torch.randn(*s, dtype=torch.bfloat16) * 1.6)(D, Hq * Dh) * (D ** -0.5)),
            "wo": _w((lambda *s: torch.randn(*s, dtype=torch.bfloat16) * 0.8)(Hq * Dh, D) * ((Hq * Dh) ** -0.5)),
        }
    _A_in = _A_setup()

    def _B_setup():
        B, S, Dm, Df = 2, 1, 448, 1792
        return {
            "x": _w((lambda *s: torch.randn(*s, dtype=torch.bfloat16) * 0.05)(B, S, Dm)),
            "w_gate": _w((lambda *s: torch.randn(*s, dtype=torch.bfloat16) * 0.4)(Dm, Df) * (Dm ** -0.5)),
            "w_up": _w((lambda *s: torch.randn(*s, dtype=torch.bfloat16) * 0.4)(Dm, Df) * (Dm ** -0.5)),
            "w_down": _w((lambda *s: torch.randn(*s, dtype=torch.bfloat16) * 0.4)(Df, Dm) * (Df ** -0.5)),
        }
    _B_in = _B_setup()

    return {
        "A_x": _A_in["x"],
        "A_k_cache": _A_in["k_cache"],
        "A_v_cache": _A_in["v_cache"],
        "A_wq": _A_in["wq"],
        "A_wo": _A_in["wo"],
        "B_x": _B_in["x"],
        "B_w_gate": _B_in["w_gate"],
        "B_w_up": _B_in["w_up"],
        "B_w_down": _B_in["w_down"],
    }

def reference(A_x, A_k_cache, A_v_cache, A_wq, A_wo, B_x, B_w_gate, B_w_up, B_w_down):
    def _A_ref(x, k_cache, v_cache, wq, wo):
        B, Sq, D = x.shape
        Hq, Dh = 16, 256
        Hkv, Sk = k_cache.shape[1], k_cache.shape[2]
        W = min(4096, max(256, Sk // 4))
        rep = Hq // Hkv
        q = (lambda x, *d: x.permute(*d))((x @ wq).reshape(B, Sq, Hq, Dh), 0, 2, 1, 3)
        k = (lambda x, n, axis: torch.repeat_interleave(x, n, dim=axis))(k_cache[:, :, Sk - W:, :], rep, axis=1)
        v = (lambda x, n, axis: torch.repeat_interleave(x, n, dim=axis))(v_cache[:, :, Sk - W:, :], rep, axis=1)
        scores = torch.einsum("bhqd,bhkd->bhqk", q, k) * (Dh ** -0.5)
        p = _softmax(scores, axis=-1)
        o = torch.einsum("bhqk,bhkd->bhqd", p, v)
        return (lambda x, *d: x.permute(*d))(o, 0, 2, 1, 3).reshape(B, Sq, Hq * Dh) @ wo

    def _B_ref(x, w_gate, w_up, w_down):
        g = torch.einsum("bsd,df->bsf", x, w_gate)
        u = torch.einsum("bsd,df->bsf", x, w_up)
        h = _gelu(g) * u
        return torch.einsum("bsf,fd->bsd", h, w_down)

    x = A_x
    xn = _layernorm(x, axis=-1)
    return x + _A_ref(xn, A_k_cache, A_v_cache, A_wq, A_wo) + _B_ref(xn, B_w_gate, B_w_up, B_w_down)
```

```asm
; @launch grid=(256,1,1) block=(768,1,1) lds=151552
.amdgcn_target "amdgcn-amd-amdhsa--gfx950"
.text
.globl parallel_sum__sliding_block_cached__glu_gated_geglu__decode_kernel
.p2align 12
.p2align 8
.type parallel_sum__sliding_block_cached__glu_gated_geglu__decode_kernel,@function
parallel_sum__sliding_block_cached__glu_gated_geglu__decode_kernel:
    s_cmp_ge_u32 s2, 256
    s_cbranch_scc1 L_end
    s_load_dwordx16 s[4:19], s[0:1], 0
    s_load_dwordx8 s[20:27], s[0:1], 64
    v_lshrrev_b32 v1, 6, v0
    v_and_b32 v0, 63, v0
    v_mov_b32 v3, 151296
    v_mov_b32 v8, 0
    v_readfirstlane_b32 s60, v1
    v_lshl_add_u32 v9, v0, 2, v3
    s_mov_b32 s74, 0
    s_mov_b32 s75, 0x11
    v_mov_b32 v10, 0xff800000
    v_cndmask_b32 v8, v8, v10, s[74:75]
    ds_write_b32 v9, v8
    v_mov_b32 v8, 1
    s_and_b32 s61, s2, 7
    s_lshr_b32 s62, s2, 3
    s_lshr_b32 s63, s62, 4
    s_and_b32 s64, s62, 15
    s_cmp_ge_u32 s60, 4
    s_cbranch_scc1 L_stream
    s_setprio 3
    s_cmp_lt_u32 s62, 30
    s_cselect_b32 s76, 1, 0
    s_cbranch_scc0 L_notask
    s_mul_i32 s67, s60, 112
    v_lshrrev_b32 v11, 2, v0
    v_add_u32 v11, s67, v11
    v_and_b32 v9, 3, v0
    v_lshlrev_b32 v9, 4, v9
    v_mul_u32_u24 v19, 28, v0
    s_cmp_lt_u32 s62, 16
    s_cbranch_scc0 L_gu
    s_lshl_b32 s66, s61, 4
    s_add_u32 s66, s66, s62
    s_movk_i32 s70, 0x2000
    s_waitcnt lgkmcnt(0)
    s_mov_b64 s[44:45], s[10:11]
    s_branch L_dec
L_gu:
    s_mul_i32 s66, s61, 14
    s_add_u32 s66, s66, s62
    s_sub_u32 s66, s66, 16
    s_movk_i32 s70, 3584
    s_waitcnt lgkmcnt(0)
    s_cmp_lt_u32 s66, 56
    s_cselect_b64 s[44:45], s[16:17], s[18:19]
    s_cselect_b32 s68, 0, 56
    s_sub_u32 s66, s66, s68
L_dec:
    s_lshl_b32 s69, s66, 6
    s_add_u32 s44, s44, s69
    s_addc_u32 s45, s45, 0
    s_mul_i32 s46, s70, 447
    s_add_u32 s46, s46, 64
    s_mov_b32 s47, 0x20000
    v_mad_u32_u24 v10, v11, s70, v9
    s_lshl_b32 s68, s70, 4
    s_mov_b32 s69, 0
    s_mov_b64 s[40:41], s[4:5]
    s_mov_b32 s42, 1792
    s_mov_b32 s43, 0x20000
    buffer_load_dwordx4 v[12:15], v19, s[40:43], 0 offen
    buffer_load_dwordx3 v[16:18], v19, s[40:43], 0 offen offset:16
    buffer_load_dwordx4 v[64:67], v10, s[44:47], s69 offen nt
    s_add_u32 s69, s69, s68
    buffer_load_dwordx4 v[68:71], v10, s[44:47], s69 offen nt
    s_add_u32 s69, s69, s68
    buffer_load_dwordx4 v[72:75], v10, s[44:47], s69 offen nt
    s_add_u32 s69, s69, s68
    buffer_load_dwordx4 v[76:79], v10, s[44:47], s69 offen nt
    s_add_u32 s69, s69, s68
    buffer_load_dwordx4 v[80:83], v10, s[44:47], s69 offen nt
    s_add_u32 s69, s69, s68
    buffer_load_dwordx4 v[84:87], v10, s[44:47], s69 offen nt
    s_add_u32 s69, s69, s68
    buffer_load_dwordx4 v[88:91], v10, s[44:47], s69 offen nt
L_notask:
    s_waitcnt lgkmcnt(0)
    s_barrier
    s_branch L_ctrl2
L_stream:
    s_sub_u32 s69, s60, 4
    s_lshl_b32 s66, s63, 3
    s_add_u32 s66, s66, s61
    s_lshl_b32 s66, s66, 24
    s_lshl_b32 s67, s64, 17
    s_add_u32 s66, s66, s67
    s_add_u32 s66, s66, 0xE00000
    s_mul_i32 s68, s2, 0x85ebca6b
    s_lshr_b32 s68, s68, 27
    s_lshl_b32 s68, s68, 3
    s_lshr_b32 s67, s69, 2
    s_and_b32 s76, s69, 3
    s_lshl_b32 s68, s68, 9
    s_lshl_b32 s71, s76, 10
    v_lshl_add_u32 v10, v0, 4, s71
    s_lshl_b32 s77, s67, 16
    s_xor_b32 s69, s68, s77
    s_lshl_b32 s78, s76, 7
    v_lshrrev_b32 v12, 3, v0
    v_lshlrev_b32 v12, 9, v12
    v_and_b32 v9, 7, v0
    v_lshl_add_u32 v12, v9, 4, v12
    v_add_u32 v12, s78, v12
    s_waitcnt lgkmcnt(0)
    s_add_u32 s28, s6, s66
    s_addc_u32 s29, s7, 0
    s_mov_b32 s30, 131072
    s_mov_b32 s31, 0x20000
    s_add_u32 s32, s8, s66
    s_addc_u32 s33, s9, 0
    s_mov_b32 s34, 131072
    s_mov_b32 s35, 0x20000
    s_lshl_b32 s72, s61, 4
    s_add_u32 s72, s72, s62
    s_lshl_b32 s72, s72, 6
    s_add_u32 s72, s72, s10
    s_bfe_u32 s73, s72, 0x30007
    s_cmp_eq_u32 s73, 3
    s_cselect_b32 s50, -1, 0
    s_bfe_u32 s73, s72, 0x60007
    s_cmp_eq_u32 s73, 63
    s_cselect_b32 s50, -1, s50
    s_mul_i32 s72, s61, 14
    s_add_u32 s72, s72, s62
    s_cmp_lt_u32 s61, 4
    s_cselect_b32 s73, s16, s18
    s_lshl_b32 s72, s72, 6
    s_add_u32 s72, s72, s73
    s_bfe_u32 s72, s72, 0x20007
    s_cmp_eq_u32 s72, 3
    s_cselect_b32 s51, -1, 0
    s_cmp_lt_u32 s62, 16
    s_cselect_b32 s50, s50, 0
    s_cselect_b32 s51, s50, s51
    s_cmp_lt_u32 s62, 30
    s_cselect_b32 vcc_lo, s51, 0
    s_mov_b32 vcc_hi, 0
    s_barrier
    s_cmp_eq_u32 s67, 0
    s_cbranch_scc1 L_kissue
    s_cmp_lg_u32 s76, 0
    s_cbranch_scc1 L_warm0
    s_call_b64 s[100:101], L_stub3
    s_call_b64 s[100:101], L_stub26
    s_call_b64 s[100:101], L_stub39
L_warm0:
    s_cmp_lg_u32 s76, 1
    s_cbranch_scc1 L_warm1
    s_call_b64 s[100:101], L_stub8
    s_call_b64 s[100:101], L_stub30
    s_call_b64 s[100:101], L_stub45
L_warm1:
    s_cmp_lg_u32 s76, 2
    s_cbranch_scc1 L_warm2
    s_call_b64 s[100:101], L_stub10
    s_call_b64 s[100:101], L_stub34
    s_nop 0
L_warm2:
    s_cmp_lg_u32 s76, 3
    s_cbranch_scc1 L_warm3
    s_call_b64 s[100:101], L_stub18
    s_call_b64 s[100:101], L_stub37
    s_nop 0
L_warm3:
    s_branch L_setup
L_kissue:
    s_setprio 1
    s_lshl_b32 s79, s76, 2
    v_add_u32 v16, s79, v3
    s_add_u32 m0, s71, 0
    s_xor_b32 s72, s68, 0
    v_xor_b32 v11, 0, v10
    buffer_load_dwordx4 v11, s[28:31], s72 offen nt lds
    s_add_u32 m0, s71, 4096
    s_xor_b32 s72, s68, 4096
    v_xor_b32 v11, 16, v10
    buffer_load_dwordx4 v11, s[28:31], s72 offen nt lds
    s_add_u32 m0, s71, 8192
    s_xor_b32 s72, s68, 8192
    v_xor_b32 v11, 32, v10
    buffer_load_dwordx4 v11, s[28:31], s72 offen nt lds
    s_add_u32 m0, s71, 12288
    s_xor_b32 s72, s68, 12288
    v_xor_b32 v11, 48, v10
    buffer_load_dwordx4 v11, s[28:31], s72 offen nt lds
    s_add_u32 m0, s71, 16384
    s_xor_b32 s72, s68, 16384
    v_xor_b32 v11, 64, v10
    buffer_load_dwordx4 v11, s[28:31], s72 offen nt lds
    s_add_u32 m0, s71, 20480
    s_xor_b32 s72, s68, 20480
    v_xor_b32 v11, 80, v10
    buffer_load_dwordx4 v11, s[28:31], s72 offen nt lds
    s_add_u32 m0, s71, 24576
    s_xor_b32 s72, s68, 24576
    v_xor_b32 v11, 96, v10
    s_cbranch_vccnz L_deep1
    s_waitcnt vmcnt(5)
L_deep1:
    buffer_load_dwordx4 v11, s[28:31], s72 offen nt lds
    s_add_u32 m0, s71, 28672
    s_xor_b32 s72, s68, 28672
    v_xor_b32 v11, 112, v10
    s_cbranch_vccnz L_deep2
    s_waitcnt vmcnt(5)
L_deep2:
    buffer_load_dwordx4 v11, s[28:31], s72 offen nt lds
    s_branch L_sk3
L_stub3:
    s_setpc_b64 s[100:101]
L_sk3:
    s_add_u32 m0, s71, 32768
    s_xor_b32 s72, s68, 32768
    v_xor_b32 v11, 128, v10
    s_cbranch_vccnz L_deep3
    s_waitcnt vmcnt(5)
L_deep3:
    buffer_load_dwordx4 v11, s[28:31], s72 offen nt lds
    s_add_u32 m0, s71, 36864
    s_xor_b32 s72, s68, 36864
    v_xor_b32 v11, 144, v10
    s_cbranch_vccnz L_deep4
    s_waitcnt vmcnt(5)
L_deep4:
    buffer_load_dwordx4 v11, s[28:31], s72 offen nt lds
    s_add_u32 m0, s71, 40960
    s_xor_b32 s72, s68, 40960
    v_xor_b32 v11, 160, v10
    s_waitcnt vmcnt(9)
    s_cbranch_vccnz L_deep5
    s_waitcnt vmcnt(5)
L_deep5:
    buffer_load_dwordx4 v11, s[28:31], s72 offen nt lds
    s_add_u32 m0, s71, 45056
    s_xor_b32 s72, s68, 45056
    v_xor_b32 v11, 176, v10
    s_waitcnt vmcnt(9)
    s_cbranch_vccnz L_deep6
    s_waitcnt vmcnt(5)
L_deep6:
    buffer_load_dwordx4 v11, s[28:31], s72 offen nt lds
    s_add_u32 m0, s71, 49152
    s_xor_b32 s72, s68, 49152
    v_xor_b32 v11, 192, v10
    s_waitcnt vmcnt(9)
    s_cbranch_vccnz L_deep7
    s_waitcnt vmcnt(5)
L_deep7:
    buffer_load_dwordx4 v11, s[28:31], s72 offen nt lds
    s_add_u32 m0, s71, 53248
    s_xor_b32 s72, s68, 53248
    v_xor_b32 v11, 208, v10
    s_waitcnt vmcnt(9)
    s_cbranch_vccnz L_deep8
    s_waitcnt vmcnt(5)
L_deep8:
    buffer_load_dwordx4 v11, s[28:31], s72 offen nt lds
    s_add_u32 m0, s71, 57344
    s_xor_b32 s72, s68, 57344
    v_xor_b32 v11, 224, v10
    s_waitcnt vmcnt(9)
    s_cbranch_vccnz L_deep9
    s_waitcnt vmcnt(5)
L_deep9:
    buffer_load_dwordx4 v11, s[28:31], s72 offen nt lds
    s_add_u32 m0, s71, 61440
    s_xor_b32 s72, s68, 61440
    v_xor_b32 v11, 240, v10
    s_waitcnt vmcnt(9)
    s_cbranch_vccnz L_deep10
    s_waitcnt vmcnt(5)
L_deep10:
    buffer_load_dwordx4 v11, s[28:31], s72 offen nt lds
    s_add_u32 m0, s71, 65536
    s_xor_b32 s72, s68, 65536
    v_xor_b32 v11, 0, v10
    s_waitcnt vmcnt(9)
    s_cbranch_vccnz L_deep11
    s_waitcnt vmcnt(5)
L_deep11:
    buffer_load_dwordx4 v11, s[28:31], s72 offen nt lds
    s_add_u32 m0, s71, 69632
    s_xor_b32 s72, s68, 69632
    v_xor_b32 v11, 16, v10
    s_waitcnt vmcnt(9)
    s_cbranch_vccnz L_deep12
    s_waitcnt vmcnt(5)
L_deep12:
    buffer_load_dwordx4 v11, s[28:31], s72 offen nt lds
    s_add_u32 m0, s71, 73728
    s_xor_b32 s72, s68, 73728
    v_xor_b32 v11, 32, v10
    s_waitcnt vmcnt(9)
    s_cbranch_vccnz L_deep13
    s_waitcnt vmcnt(5)
L_deep13:
    buffer_load_dwordx4 v11, s[28:31], s72 offen nt lds
    s_add_u32 m0, s71, 77824
    s_xor_b32 s72, s68, 77824
    v_xor_b32 v11, 48, v10
    s_waitcnt vmcnt(9)
    s_cbranch_vccnz L_deep14
    s_waitcnt vmcnt(5)
L_deep14:
    buffer_load_dwordx4 v11, s[28:31], s72 offen nt lds
    s_add_u32 m0, s71, 81920
    s_xor_b32 s72, s68, 81920
    v_xor_b32 v11, 64, v10
    s_waitcnt vmcnt(9)
    s_cbranch_vccnz L_deep15
    s_waitcnt vmcnt(5)
L_deep15:
    buffer_load_dwordx4 v11, s[28:31], s72 offen nt lds
    s_add_u32 m0, s71, 86016
    s_xor_b32 s72, s68, 86016
    v_xor_b32 v11, 80, v10
    s_waitcnt vmcnt(9)
    s_cbranch_vccnz L_deep16
    s_waitcnt vmcnt(5)
L_deep16:
    buffer_load_dwordx4 v11, s[28:31], s72 offen nt lds
    s_waitcnt vmcnt(6)
    s_mov_b64 exec, 1
    ds_add_u32 v3, v8 offset:8
    s_mov_b64 exec, -1
    s_add_u32 m0, s71, 90112
    s_xor_b32 s72, s68, 90112
    v_xor_b32 v11, 96, v10
    s_waitcnt vmcnt(9)
    s_cbranch_vccnz L_deep17
    s_waitcnt vmcnt(5)
L_deep17:
    buffer_load_dwordx4 v11, s[28:31], s72 offen nt lds
    s_add_u32 m0, s71, 94208
    s_xor_b32 s72, s68, 94208
    v_xor_b32 v11, 112, v10
    s_waitcnt vmcnt(9)
    s_cbranch_vccnz L_deep18
    s_waitcnt vmcnt(5)
L_deep18:
    buffer_load_dwordx4 v11, s[28:31], s72 offen nt lds
    s_add_u32 m0, s71, 98304
    s_xor_b32 s72, s68, 98304
    v_xor_b32 v11, 128, v10
    s_waitcnt vmcnt(9)
    s_cbranch_vccnz L_deep19
    s_waitcnt vmcnt(5)
L_deep19:
    buffer_load_dwordx4 v11, s[28:31], s72 offen nt lds
    s_add_u32 m0, s71, 102400
    s_xor_b32 s72, s68, 102400
    v_xor_b32 v11, 144, v10
    s_waitcnt vmcnt(9)
    s_cbranch_vccnz L_deep20
    s_waitcnt vmcnt(5)
L_deep20:
    buffer_load_dwordx4 v11, s[28:31], s72 offen nt lds
    s_add_u32 m0, s71, 106496
    s_xor_b32 s72, s68, 106496
    v_xor_b32 v11, 160, v10
    s_waitcnt vmcnt(9)
    s_cbranch_vccnz L_deep21
    s_waitcnt vmcnt(5)
L_deep21:
    buffer_load_dwordx4 v11, s[28:31], s72 offen nt lds
    s_add_u32 m0, s71, 110592
    s_xor_b32 s72, s68, 110592
    v_xor_b32 v11, 176, v10
    s_waitcnt vmcnt(9)
    s_cbranch_vccnz L_deep22
    s_waitcnt vmcnt(5)
L_deep22:
    buffer_load_dwordx4 v11, s[28:31], s72 offen nt lds
    s_branch L_sk8
L_stub8:
    s_setpc_b64 s[100:101]
L_sk8:
    s_add_u32 m0, s71, 114688
    s_xor_b32 s72, s68, 114688
    v_xor_b32 v11, 192, v10
    s_waitcnt vmcnt(9)
    s_cbranch_vccnz L_deep23
    s_waitcnt vmcnt(5)
L_deep23:
    buffer_load_dwordx4 v11, s[28:31], s72 offen nt lds
    s_add_u32 m0, s71, 118784
    s_xor_b32 s72, s68, 118784
    v_xor_b32 v11, 208, v10
    s_waitcnt vmcnt(9)
    s_cbranch_vccnz L_deep24
    s_waitcnt vmcnt(5)
L_deep24:
    buffer_load_dwordx4 v11, s[28:31], s72 offen nt lds
    s_mov_b64 exec, 1
    ds_add_u32 v3, v8 offset:56
    s_mov_b64 exec, -1
L_notrig25:
    s_add_u32 m0, s71, 122880
    s_xor_b32 s72, s68, 122880
    v_xor_b32 v11, 224, v10
    s_waitcnt vmcnt(9)
    s_cbranch_vccnz L_deep26
    s_waitcnt vmcnt(5)
L_deep26:
    buffer_load_dwordx4 v11, s[28:31], s72 offen nt lds
    s_add_u32 m0, s71, 126976
    s_xor_b32 s72, s68, 126976
    v_xor_b32 v11, 240, v10
    s_mov_b32 vcc_lo, s50
    s_waitcnt vmcnt(9)
    s_cbranch_vccnz L_deep27
    s_waitcnt vmcnt(5)
L_deep27:
    buffer_load_dwordx4 v11, s[28:31], s72 offen nt lds
L_vissue:
    s_waitcnt vmcnt(9)
    s_cbranch_vccnz L_deep28
    s_waitcnt vmcnt(5)
L_deep28:
    s_xor_b32 s72, s69, 0
    buffer_load_dwordx4 v[64:67], v12, s[32:35], s72 offen nt
    s_waitcnt vmcnt(9)
    s_cbranch_vccnz L_deep29
    s_waitcnt vmcnt(5)
L_deep29:
    s_xor_b32 s72, s69, 4096
    buffer_load_dwordx4 v[68:71], v12, s[32:35], s72 offen nt
    s_waitcnt vmcnt(9)
    s_cbranch_vccnz L_deep30
    s_waitcnt vmcnt(5)
L_deep30:
    s_xor_b32 s72, s69, 8192
    buffer_load_dwordx4 v[72:75], v12, s[32:35], s72 offen nt
    s_waitcnt vmcnt(9)
    s_cbranch_vccnz L_deep31
    s_waitcnt vmcnt(5)
L_deep31:
    s_xor_b32 s72, s69, 12288
    buffer_load_dwordx4 v[76:79], v12, s[32:35], s72 offen nt
    s_waitcnt vmcnt(9)
    s_cbranch_vccnz L_deep32
    s_waitcnt vmcnt(5)
L_deep32:
    s_xor_b32 s72, s69, 16384
    buffer_load_dwordx4 v[80:83], v12, s[32:35], s72 offen nt
    s_waitcnt vmcnt(9)
    s_cbranch_vccnz L_deep33
    s_waitcnt vmcnt(5)
L_deep33:
    s_xor_b32 s72, s69, 20480
    buffer_load_dwordx4 v[84:87], v12, s[32:35], s72 offen nt
    s_cmp_eq_u32 s67, 0
    s_cbranch_scc0 L_nosig
    s_waitcnt vmcnt(6)
    s_mov_b64 exec, 1
    ds_add_u32 v3, v8 offset:12
    s_mov_b64 exec, -1
L_nosig:
    s_waitcnt vmcnt(9)
    s_cbranch_vccnz L_deep34
    s_waitcnt vmcnt(5)
L_deep34:
    s_xor_b32 s72, s69, 24576
    buffer_load_dwordx4 v[88:91], v12, s[32:35], s72 offen nt
    s_waitcnt vmcnt(9)
    s_cbranch_vccnz L_deep35
    s_waitcnt vmcnt(5)
L_deep35:
    s_xor_b32 s72, s69, 28672
    buffer_load_dwordx4 v[92:95], v12, s[32:35], s72 offen nt
    s_waitcnt vmcnt(9)
    s_cbranch_vccnz L_deep36
    s_waitcnt vmcnt(5)
L_deep36:
    s_xor_b32 s72, s69, 32768
    buffer_load_dwordx4 v[96:99], v12, s[32:35], s72 offen nt
    s_waitcnt vmcnt(9)
    s_cbranch_vccnz L_deep37
    s_waitcnt vmcnt(5)
L_deep37:
    s_xor_b32 s72, s69, 36864
    buffer_load_dwordx4 v[100:103], v12, s[32:35], s72 offen nt
    s_waitcnt vmcnt(9)
    s_cbranch_vccnz L_deep38
    s_waitcnt vmcnt(5)
L_deep38:
    s_xor_b32 s72, s69, 40960
    buffer_load_dwordx4 v[104:107], v12, s[32:35], s72 offen nt
    s_waitcnt vmcnt(9)
    s_cbranch_vccnz L_deep39
    s_waitcnt vmcnt(5)
L_deep39:
    s_xor_b32 s72, s69, 45056
    buffer_load_dwordx4 v[108:111], v12, s[32:35], s72 offen nt
    s_waitcnt vmcnt(9)
    s_cbranch_vccnz L_deep40
    s_waitcnt vmcnt(5)
L_deep40:
    s_xor_b32 s72, s69, 49152
    buffer_load_dwordx4 v[112:115], v12, s[32:35], s72 offen nt
    s_cmp_eq_u32 s67, 0
    s_cbranch_scc1 L_nop
    ds_read_b32 v9, v3 offset:28
    ds_read_b32 v21, v16 offset:32
    s_waitcnt lgkmcnt(0)
    v_and_b32 v9, v9, v21
    s_nop 0
    v_readfirstlane_b32 s77, v9
    s_cmp_eq_u32 s77, 0
    s_cbranch_scc1 L_nop
    ds_read_b128 v[128:131], v14 offset:0
    ds_read_b128 v[132:135], v14 offset:16
    ds_read_b128 v[136:139], v14 offset:32
    ds_read_b128 v[140:143], v14 offset:48
    ds_read_b128 v[144:147], v14 offset:64
    ds_read_b128 v[148:151], v14 offset:80
    ds_read_b128 v[152:155], v14 offset:96
    ds_read_b128 v[156:159], v14 offset:112
    ds_read_b128 v[32:35], v15
    ds_read_b128 v[36:39], v15 offset:16
    ds_read_b64 v[40:41], v18 offset:136
    ds_read_b32 v42, v3 offset:60
L_nop:
    s_waitcnt vmcnt(9)
    s_cbranch_vccnz L_deep41
    s_waitcnt vmcnt(5)
L_deep41:
    s_xor_b32 s72, s69, 53248
    buffer_load_dwordx4 v[116:119], v12, s[32:35], s72 offen nt
    s_waitcnt vmcnt(9)
    s_cbranch_vccnz L_deep42
    s_waitcnt vmcnt(5)
L_deep42:
    s_xor_b32 s72, s69, 57344
    buffer_load_dwordx4 v[120:123], v12, s[32:35], s72 offen nt
    s_cmp_eq_u32 s67, 0
    s_cbranch_scc1 L_nobi
    s_mov_b64 exec, 1
    ds_add_u32 v3, v8 offset:80
    s_mov_b64 exec, -1
L_nobi:
    s_waitcnt vmcnt(9)
    s_cbranch_vccnz L_deep43
    s_waitcnt vmcnt(5)
L_deep43:
    s_xor_b32 s72, s69, 61440
    buffer_load_dwordx4 v[124:127], v12, s[32:35], s72 offen nt
    s_cmp_eq_u32 s67, 0
    s_cbranch_scc0 L_noai
    s_mov_b64 exec, 1
    ds_add_u32 v16, v8 offset:64
    s_mov_b64 exec, -1
L_noai:
    s_branch L_stream2
    .p2align 12
L_stub10:
    s_setpc_b64 s[100:101]
L_sk10:
L_ctrl2:
    s_load_dword s3, s[26:27], 0
    s_load_dword s65, s[26:27], 921600
    v_and_b32 v1, 15, v0
    v_lshrrev_b32 v2, 4, v0
    v_and_b32 v9, 1, v0
    v_lshlrev_b32 v9, 4, v9
    v_mov_b32 v10, 0xffff
    v_lshlrev_b32 v9, v9, v10
    s_mov_b32 s74, 0x3030303
    s_mov_b32 s75, s74
    v_cndmask_b32 v4, 0, v9, s[74:75]
    s_mov_b32 s74, 0xc0c0c0c
    s_mov_b32 s75, s74
    v_cndmask_b32 v5, 0, v9, s[74:75]
    s_mov_b32 s74, 0x30303030
    s_mov_b32 s75, s74
    v_cndmask_b32 v6, 0, v9, s[74:75]
    s_mov_b32 s74, 0xc0c0c0c0
    s_mov_b32 s75, s74
    v_cndmask_b32 v7, 0, v9, s[74:75]
    s_mov_b64 s[36:37], s[26:27]
    s_mov_b32 s38, 921856
    s_mov_b32 s39, 0x20000
    s_getreg_b32 s79, hwreg(HW_REG_XCC_ID, 0, 4)
    s_cmp_eq_u32 s76, 0
    s_cbranch_scc0 L_ln
    s_waitcnt lgkmcnt(0)
    s_add_u32 s65, s65, 1
    s_cmp_eq_u32 s65, s3
    s_addc_u32 s65, s65, 0
    s_cmp_lg_u32 s60, 0
    s_cbranch_scc1 L_s1skip
    v_lshlrev_b32 v10, 4, v0
    v_mov_b32 v40, 0
    v_mov_b32 v41, 0
    s_mov_b64 exec, 0xffff
    s_branch L_s1pub
L_ln:
    s_waitcnt vmcnt(7)
    v_lshlrev_b32 v20, 16, v12
    v_and_b32 v21, 0xffff0000, v12
    v_lshlrev_b32 v22, 16, v13
    v_and_b32 v23, 0xffff0000, v13
    v_lshlrev_b32 v24, 16, v14
    v_and_b32 v25, 0xffff0000, v14
    v_lshlrev_b32 v26, 16, v15
    v_and_b32 v27, 0xffff0000, v15
    v_lshlrev_b32 v28, 16, v16
    v_and_b32 v29, 0xffff0000, v16
    v_lshlrev_b32 v30, 16, v17
    v_and_b32 v31, 0xffff0000, v17
    v_lshlrev_b32 v32, 16, v18
    v_and_b32 v33, 0xffff0000, v18
    v_pk_add_f32 v[34:35], v[20:21], v[22:23]
    v_pk_add_f32 v[34:35], v[34:35], v[24:25]
    v_pk_add_f32 v[34:35], v[34:35], v[26:27]
    v_pk_add_f32 v[34:35], v[34:35], v[28:29]
    v_pk_add_f32 v[34:35], v[34:35], v[30:31]
    v_pk_add_f32 v[34:35], v[34:35], v[32:33]
    v_add_f32 v34, v34, v35
    s_nop 1
    v_add_f32_dpp v34, v34, v34 quad_perm:[1,0,3,2] row_mask:0xf bank_mask:0xf
    s_nop 1
    v_add_f32_dpp v34, v34, v34 quad_perm:[2,3,0,1] row_mask:0xf bank_mask:0xf
    s_nop 1
    v_add_f32_dpp v34, v34, v34 row_half_mirror row_mask:0xf bank_mask:0xf
    s_nop 1
    v_add_f32_dpp v34, v34, v34 row_mirror row_mask:0xf bank_mask:0xf
    v_mov_b32 v35, v34
    s_nop 1
    v_permlane16_swap_b32 v34, v35
    s_nop 0
    v_add_f32 v34, v34, v35
    v_mul_f32 v34, 0x3b124925, v34
    v_sub_f32 v36, v20, v34
    v_sub_f32 v37, v21, v34
    v_mul_f32 v38, v36, v36
    v_mul_f32 v39, v37, v37
    v_sub_f32 v36, v22, v34
    v_sub_f32 v37, v23, v34
    v_fmac_f32 v38, v36, v36
    v_fmac_f32 v39, v37, v37
    v_sub_f32 v36, v24, v34
    v_sub_f32 v37, v25, v34
    v_fmac_f32 v38, v36, v36
    v_fmac_f32 v39, v37, v37
    v_sub_f32 v36, v26, v34
    v_sub_f32 v37, v27, v34
    v_fmac_f32 v38, v36, v36
    v_fmac_f32 v39, v37, v37
    v_sub_f32 v36, v28, v34
    v_sub_f32 v37, v29, v34
    v_fmac_f32 v38, v36, v36
    v_fmac_f32 v39, v37, v37
    v_sub_f32 v36, v30, v34
    v_sub_f32 v37, v31, v34
    v_fmac_f32 v38, v36, v36
    v_fmac_f32 v39, v37, v37
    v_sub_f32 v36, v32, v34
    v_sub_f32 v37, v33, v34
    v_fmac_f32 v38, v36, v36
    v_fmac_f32 v39, v37, v37
    v_add_f32 v38, v38, v39
    s_nop 1
    v_add_f32_dpp v38, v38, v38 quad_perm:[1,0,3,2] row_mask:0xf bank_mask:0xf
    s_nop 1
    v_add_f32_dpp v38, v38, v38 quad_perm:[2,3,0,1] row_mask:0xf bank_mask:0xf
    s_nop 1
    v_add_f32_dpp v38, v38, v38 row_half_mirror row_mask:0xf bank_mask:0xf
    s_nop 1
    v_add_f32_dpp v38, v38, v38 row_mirror row_mask:0xf bank_mask:0xf
    v_mov_b32 v39, v38
    s_nop 1
    v_permlane16_swap_b32 v38, v39
    s_nop 0
    v_add_f32 v38, v38, v39
    v_mul_f32 v38, 0x3b124925, v38
    v_cvt_pk_bf16_f32 v36, v34, v38
    v_lshlrev_b32 v34, 16, v36
    v_and_b32 v38, 0xffff0000, v36
    v_add_f32 v38, 0x3727c5ac, v38
    v_cvt_pk_bf16_f32 v38, v38, v38
    v_lshlrev_b32 v38, 16, v38
    v_sqrt_f32 v38, v38
    s_nop 0
    v_cvt_pk_bf16_f32 v38, v38, v38
    v_lshlrev_b32 v38, 16, v38
    v_rcp_f32 v38, v38
    s_mov_b32 s74, 0xffff0000
    v_sub_f32 v20, v20, v34
    v_sub_f32 v21, v21, v34
    v_cvt_pk_bf16_f32 v36, v20, v21
    v_lshlrev_b32 v20, 16, v36
    v_and_b32 v21, s74, v36
    v_mul_f32 v20, v20, v38
    v_mul_f32 v21, v21, v38
    v_cvt_pk_bf16_f32 v20, v20, v20
    v_cvt_pk_bf16_f32 v21, v21, v21
    v_sub_f32 v22, v22, v34
    v_sub_f32 v23, v23, v34
    v_cvt_pk_bf16_f32 v36, v22, v23
    v_lshlrev_b32 v22, 16, v36
    v_and_b32 v23, s74, v36
    v_mul_f32 v22, v22, v38
    v_mul_f32 v23, v23, v38
    v_cvt_pk_bf16_f32 v22, v22, v22
    v_cvt_pk_bf16_f32 v23, v23, v23
    v_sub_f32 v24, v24, v34
    v_sub_f32 v25, v25, v34
    v_cvt_pk_bf16_f32 v36, v24, v25
    v_lshlrev_b32 v24, 16, v36
    v_and_b32 v25, s74, v36
    v_mul_f32 v24, v24, v38
    v_mul_f32 v25, v25, v38
    v_cvt_pk_bf16_f32 v24, v24, v24
    v_cvt_pk_bf16_f32 v25, v25, v25
    v_sub_f32 v26, v26, v34
    v_sub_f32 v27, v27, v34
    v_cvt_pk_bf16_f32 v36, v26, v27
    v_lshlrev_b32 v26, 16, v36
    v_and_b32 v27, s74, v36
    v_mul_f32 v26, v26, v38
    v_mul_f32 v27, v27, v38
    v_cvt_pk_bf16_f32 v26, v26, v26
    v_cvt_pk_bf16_f32 v27, v27, v27
    v_sub_f32 v28, v28, v34
    v_sub_f32 v29, v29, v34
    v_cvt_pk_bf16_f32 v36, v28, v29
    v_lshlrev_b32 v28, 16, v36
    v_and_b32 v29, s74, v36
    v_mul_f32 v28, v28, v38
    v_mul_f32 v29, v29, v38
    v_cvt_pk_bf16_f32 v28, v28, v28
    v_cvt_pk_bf16_f32 v29, v29, v29
    v_sub_f32 v30, v30, v34
    v_sub_f32 v31, v31, v34
    v_cvt_pk_bf16_f32 v36, v30, v31
    v_lshlrev_b32 v30, 16, v36
    v_and_b32 v31, s74, v36
    v_mul_f32 v30, v30, v38
    v_mul_f32 v31, v31, v38
    v_cvt_pk_bf16_f32 v30, v30, v30
    v_cvt_pk_bf16_f32 v31, v31, v31
    v_sub_f32 v32, v32, v34
    v_sub_f32 v33, v33, v34
    v_cvt_pk_bf16_f32 v36, v32, v33
    v_lshlrev_b32 v32, 16, v36
    v_and_b32 v33, s74, v36
    v_mul_f32 v32, v32, v38
    v_mul_f32 v33, v33, v38
    v_cvt_pk_bf16_f32 v32, v32, v32
    v_cvt_pk_bf16_f32 v33, v33, v33
    s_branch L_sk18
L_stub18:
    s_setpc_b64 s[100:101]
L_sk18:
    v_mul_u32_u24 v9, 56, v0
    v_add_u32 v9, 131072, v9
    ds_write_b64 v9, v[20:21] offset:0
    ds_write_b64 v9, v[22:23] offset:8
    ds_write_b64 v9, v[24:25] offset:16
    ds_write_b64 v9, v[26:27] offset:24
    ds_write_b64 v9, v[28:29] offset:32
    ds_write_b64 v9, v[30:31] offset:40
    ds_write_b64 v9, v[32:33] offset:48
    s_lshl_b32 s68, s67, 2
    s_add_u32 s68, s68, 131072
    v_bfe_u32 v9, v0, 3, 1
    v_mul_u32_u24 v9, 1792, v9
    v_lshl_add_u32 v9, v2, 4, v9
    v_add_u32 v9, s68, v9
    s_waitcnt lgkmcnt(0)
    s_add_u32 s65, s65, 1
    s_cmp_eq_u32 s65, s3
    s_addc_u32 s65, s65, 0
    ds_read_b128 v[20:23], v9 offset:0
    ds_read_b128 v[24:27], v9 offset:64
    ds_read_b128 v[28:31], v9 offset:128
    ds_read_b128 v[32:35], v9 offset:192
    ds_read_b128 v[36:39], v9 offset:256
    ds_read_b128 v[40:43], v9 offset:320
    ds_read_b128 v[44:47], v9 offset:384
    s_waitcnt lgkmcnt(0)
    v_and_b32 v48, v4, v20
    v_and_b32 v49, v5, v20
    v_and_b32 v50, v6, v20
    v_and_b32 v51, v7, v20
    v_and_b32 v52, v4, v21
    v_and_b32 v53, v5, v21
    v_and_b32 v54, v6, v21
    v_and_b32 v55, v7, v21
    s_waitcnt vmcnt(6)
    v_mfma_f32_16x16x32_bf16 v[96:99], v[48:51], v[64:67], 0
    v_and_b32 v48, v4, v22
    v_and_b32 v49, v5, v22
    v_and_b32 v50, v6, v22
    v_and_b32 v51, v7, v22
    v_mfma_f32_16x16x32_bf16 v[100:103], v[52:55], v[64:67], 0
    v_and_b32 v52, v4, v23
    v_and_b32 v53, v5, v23
    v_and_b32 v54, v6, v23
    v_and_b32 v55, v7, v23
    v_mfma_f32_16x16x32_bf16 v[104:107], v[48:51], v[64:67], 0
    v_and_b32 v48, v4, v24
    v_and_b32 v49, v5, v24
    v_and_b32 v50, v6, v24
    v_and_b32 v51, v7, v24
    v_mfma_f32_16x16x32_bf16 v[108:111], v[52:55], v[64:67], 0
    v_and_b32 v52, v4, v25
    v_and_b32 v53, v5, v25
    v_and_b32 v54, v6, v25
    v_and_b32 v55, v7, v25
    s_waitcnt vmcnt(5)
    v_mfma_f32_16x16x32_bf16 v[96:99], v[48:51], v[68:71], v[96:99]
    v_and_b32 v48, v4, v26
    v_and_b32 v49, v5, v26
    v_and_b32 v50, v6, v26
    v_and_b32 v51, v7, v26
    v_mfma_f32_16x16x32_bf16 v[100:103], v[52:55], v[68:71], v[100:103]
    v_and_b32 v52, v4, v27
    v_and_b32 v53, v5, v27
    v_and_b32 v54, v6, v27
    v_and_b32 v55, v7, v27
    v_mfma_f32_16x16x32_bf16 v[104:107], v[48:51], v[68:71], v[104:107]
    v_and_b32 v48, v4, v28
    v_and_b32 v49, v5, v28
    v_and_b32 v50, v6, v28
    v_and_b32 v51, v7, v28
    v_mfma_f32_16x16x32_bf16 v[108:111], v[52:55], v[68:71], v[108:111]
    v_and_b32 v52, v4, v29
    v_and_b32 v53, v5, v29
    v_and_b32 v54, v6, v29
    v_and_b32 v55, v7, v29
    s_waitcnt vmcnt(4)
    v_mfma_f32_16x16x32_bf16 v[96:99], v[48:51], v[72:75], v[96:99]
    v_and_b32 v48, v4, v30
    v_and_b32 v49, v5, v30
    v_and_b32 v50, v6, v30
    v_and_b32 v51, v7, v30
    v_mfma_f32_16x16x32_bf16 v[100:103], v[52:55], v[72:75], v[100:103]
    v_and_b32 v52, v4, v31
    v_and_b32 v53, v5, v31
    v_and_b32 v54, v6, v31
    v_and_b32 v55, v7, v31
    v_mfma_f32_16x16x32_bf16 v[104:107], v[48:51], v[72:75], v[104:107]
    v_and_b32 v48, v4, v32
    v_and_b32 v49, v5, v32
    v_and_b32 v50, v6, v32
    v_and_b32 v51, v7, v32
    v_mfma_f32_16x16x32_bf16 v[108:111], v[52:55], v[72:75], v[108:111]
    v_and_b32 v52, v4, v33
    v_and_b32 v53, v5, v33
    v_and_b32 v54, v6, v33
    v_and_b32 v55, v7, v33
    s_waitcnt vmcnt(3)
    v_mfma_f32_16x16x32_bf16 v[96:99], v[48:51], v[76:79], v[96:99]
    v_and_b32 v48, v4, v34
    v_and_b32 v49, v5, v34
    v_and_b32 v50, v6, v34
    v_and_b32 v51, v7, v34
    v_mfma_f32_16x16x32_bf16 v[100:103], v[52:55], v[76:79], v[100:103]
    v_and_b32 v52, v4, v35
    v_and_b32 v53, v5, v35
    v_and_b32 v54, v6, v35
    v_and_b32 v55, v7, v35
    v_mfma_f32_16x16x32_bf16 v[104:107], v[48:51], v[76:79], v[104:107]
    v_and_b32 v48, v4, v36
    v_and_b32 v49, v5, v36
    v_and_b32 v50, v6, v36
    v_and_b32 v51, v7, v36
    v_mfma_f32_16x16x32_bf16 v[108:111], v[52:55], v[76:79], v[108:111]
    v_and_b32 v52, v4, v37
    v_and_b32 v53, v5, v37
    v_and_b32 v54, v6, v37
    v_and_b32 v55, v7, v37
    s_waitcnt vmcnt(2)
    v_mfma_f32_16x16x32_bf16 v[96:99], v[48:51], v[80:83], v[96:99]
    v_and_b32 v48, v4, v38
    v_and_b32 v49, v5, v38
    v_and_b32 v50, v6, v38
    v_and_b32 v51, v7, v38
    v_mfma_f32_16x16x32_bf16 v[100:103], v[52:55], v[80:83], v[100:103]
    v_and_b32 v52, v4, v39
    v_and_b32 v53, v5, v39
    v_and_b32 v54, v6, v39
    v_and_b32 v55, v7, v39
    v_mfma_f32_16x16x32_bf16 v[104:107], v[48:51], v[80:83], v[104:107]
    v_and_b32 v48, v4, v40
    v_and_b32 v49, v5, v40
    v_and_b32 v50, v6, v40
    v_and_b32 v51, v7, v40
    v_mfma_f32_16x16x32_bf16 v[108:111], v[52:55], v[80:83], v[108:111]
    v_and_b32 v52, v4, v41
    v_and_b32 v53, v5, v41
    v_and_b32 v54, v6, v41
    v_and_b32 v55, v7, v41
    s_waitcnt vmcnt(1)
    v_mfma_f32_16x16x32_bf16 v[96:99], v[48:51], v[84:87], v[96:99]
    v_and_b32 v48, v4, v42
    v_and_b32 v49, v5, v42
    v_and_b32 v50, v6, v42
    v_and_b32 v51, v7, v42
    v_mfma_f32_16x16x32_bf16 v[100:103], v[52:55], v[84:87], v[100:103]
    v_and_b32 v52, v4, v43
    v_and_b32 v53, v5, v43
    v_and_b32 v54, v6, v43
    v_and_b32 v55, v7, v43
    v_mfma_f32_16x16x32_bf16 v[104:107], v[48:51], v[84:87], v[104:107]
    v_and_b32 v48, v4, v44
    v_and_b32 v49, v5, v44
    v_and_b32 v50, v6, v44
    v_and_b32 v51, v7, v44
    v_mfma_f32_16x16x32_bf16 v[108:111], v[52:55], v[84:87], v[108:111]
    v_and_b32 v52, v4, v45
    v_and_b32 v53, v5, v45
    v_and_b32 v54, v6, v45
    v_and_b32 v55, v7, v45
    s_waitcnt vmcnt(0)
    v_mfma_f32_16x16x32_bf16 v[96:99], v[48:51], v[88:91], v[96:99]
    v_and_b32 v48, v4, v46
    v_and_b32 v49, v5, v46
    v_and_b32 v50, v6, v46
    v_and_b32 v51, v7, v46
    v_mfma_f32_16x16x32_bf16 v[100:103], v[52:55], v[88:91], v[100:103]
    v_and_b32 v52, v4, v47
    v_and_b32 v53, v5, v47
    v_and_b32 v54, v6, v47
    v_and_b32 v55, v7, v47
    v_mfma_f32_16x16x32_bf16 v[104:107], v[48:51], v[88:91], v[104:107]
    s_nop 1
    v_mfma_f32_16x16x32_bf16 v[108:111], v[52:55], v[88:91], v[108:111]
    s_branch L_sk26
L_stub26:
    s_setpc_b64 s[100:101]
L_sk26:
    s_lshl_b32 s68, s60, 8
    s_add_u32 s68, s68, 134656
    v_lshrrev_b32 v9, 5, v0
    v_lshlrev_b32 v9, 7, v9
    v_and_b32 v10, 3, v0
    v_lshl_add_u32 v9, v10, 5, v9
    v_and_b32 v10, 1, v2
    v_lshl_add_u32 v9, v10, 4, v9
    v_add_u32 v9, s68, v9
    v_add_f32_dpp v96, v100, v96 row_shl:4 row_mask:0xf bank_mask:0x1
    v_add_f32_dpp v97, v101, v97 row_shl:4 row_mask:0xf bank_mask:0x1
    v_add_f32_dpp v98, v102, v98 row_shl:4 row_mask:0xf bank_mask:0x1
    v_add_f32_dpp v99, v103, v99 row_shl:4 row_mask:0xf bank_mask:0x1
    v_add_f32_dpp v96, v104, v96 row_shl:8 row_mask:0xf bank_mask:0x1
    v_add_f32_dpp v97, v105, v97 row_shl:8 row_mask:0xf bank_mask:0x1
    v_add_f32_dpp v98, v106, v98 row_shl:8 row_mask:0xf bank_mask:0x1
    v_add_f32_dpp v99, v107, v99 row_shl:8 row_mask:0xf bank_mask:0x1
    v_add_f32_dpp v96, v108, v96 row_shl:12 row_mask:0xf bank_mask:0x1
    v_add_f32_dpp v97, v109, v97 row_shl:12 row_mask:0xf bank_mask:0x1
    v_add_f32_dpp v98, v110, v98 row_shl:12 row_mask:0xf bank_mask:0x1
    v_add_f32_dpp v99, v111, v99 row_shl:12 row_mask:0xf bank_mask:0x1
    s_mov_b32 exec_lo, 0x000f000f
    s_mov_b32 exec_hi, 0x000f000f
    ds_write_b128 v9, v[96:99]
    s_mov_b64 exec, 1
    ds_add_rtn_u32 v10, v3, v8 offset:0
    s_mov_b64 exec, -1
    s_waitcnt lgkmcnt(0)
    v_readfirstlane_b32 s73, v10
    s_cmp_eq_u32 s73, 3
    s_cbranch_scc0 L_s1skip
    v_lshlrev_b32 v10, 4, v0
    v_add_u32 v9, 134656, v10
    s_mov_b64 exec, 0xffff
    ds_read_b128 v[20:23], v9 offset:0
    ds_read_b128 v[24:27], v9 offset:256
    ds_read_b128 v[28:31], v9 offset:512
    ds_read_b128 v[32:35], v9 offset:768
    s_waitcnt lgkmcnt(0)
    v_pk_add_f32 v[20:21], v[20:21], v[24:25]
    v_pk_add_f32 v[22:23], v[22:23], v[26:27]
    v_pk_add_f32 v[20:21], v[20:21], v[28:29]
    v_pk_add_f32 v[22:23], v[22:23], v[30:31]
    v_pk_add_f32 v[20:21], v[20:21], v[32:33]
    v_pk_add_f32 v[22:23], v[22:23], v[34:35]
    v_cvt_pk_bf16_f32 v40, v20, v21
    v_cvt_pk_bf16_f32 v41, v22, v23
L_s1pub:
    s_lshl_b32 s68, s61, 5
    s_add_u32 s68, s68, s62
    s_lshl_b32 s68, s68, 8
    s_add_u32 s68, s68, 4096
    v_mov_b32 v42, s79
    v_mov_b32 v43, s65
    buffer_store_dwordx4 v[40:43], v10, s[36:39], s68 offen sc1
    s_mov_b64 exec, -1
L_s1skip:
    s_and_b32 s66, s62, 3
    s_lshr_b32 s67, s62, 2
    s_lshl_b32 s68, s61, 3
    s_add_u32 s68, s68, s67
    s_lshl_b32 s68, s68, 2
    s_add_u32 s68, s68, s60
    s_mul_i32 s69, s68, 14336
    s_add_u32 s48, s12, s69
    s_addc_u32 s49, s13, 0
    s_mov_b32 s50, 14336
    s_mov_b32 s51, 0x20000
    s_mul_i32 s69, s68, 7168
    s_cmp_lt_u32 s68, 224
    s_cselect_b32 s69, s69, 0
    s_cselect_b32 s54, 7168, 0
    s_add_u32 s52, s20, s69
    s_addc_u32 s53, s21, 0
    s_mov_b32 s55, 0x20000
    s_lshl_b32 s69, s66, 8
    v_lshl_add_u32 v9, v1, 4, s69
    v_cmp_gt_u32 vcc, 896, v9
    v_mul_u32_u24 v10, 896, v2
    v_add_u32 v10, v10, v9
    s_movk_i32 s69, 7168
    v_mul_u32_u24 v12, 1792, v2
    v_add_u32 v12, v12, v9
    v_mov_b32 v9, 0x7fffffff
    v_cndmask_b32 v126, v9, v10, vcc
    v_cndmask_b32 v127, v9, v12, vcc
    s_min_u32 s68, s68, 223
    s_lshr_b32 s69, s68, 2
    s_mul_i32 s77, s69, 4682
    s_lshr_b32 s77, s77, 16
    s_mul_i32 s77, s77, 18
    s_add_u32 s69, s69, s77
    s_lshl_b32 s69, s69, 8
    s_and_b32 s68, s68, 3
    s_lshl_b32 s68, s68, 5
    s_add_u32 s68, s68, s69
    s_add_u32 s68, s68, 8192
    v_bfe_u32 v14, v0, 3, 1
    v_lshlrev_b32 v61, 7, v14
    v_lshrrev_b32 v9, 5, v0
    v_lshl_add_u32 v61, v9, 4, v61
    v_and_b32 v10, 1, v0
    v_lshlrev_b32 v10, 15, v10
    v_add3_u32 v61, v61, v10, s68
    s_lshl_b32 s68, s61, 5
    s_lshl_b32 s69, s60, 2
    s_add_u32 s68, s68, s69
    s_lshl_b32 s68, s68, 8
    s_lshl_b32 s69, s63, 7
    s_add_u32 s68, s68, s69
    s_add_u32 s68, s68, 4096
    v_bfe_u32 v12, v0, 3, 2
    v_lshl_add_u32 v12, v9, 4, v12
    v_lshlrev_b32 v12, 8, v12
    v_and_b32 v9, 7, v0
    v_lshl_add_u32 v12, v9, 4, v12
    v_add_u32 v12, s68, v12
    v_and_b32 v62, 31, v0
    v_lshlrev_b32 v63, 3, v62
    v_and_b32 v9, 3, v1
    v_xor_b32 v9, v9, v2
    v_lshlrev_b32 v9, 4, v9
    v_lshl_add_u32 v9, v1, 12, v9
    s_lshl_b32 s68, s60, 10
    v_add_u32 v9, s68, v9
    v_lshrrev_b32 v15, 2, v1
    v_xor_b32 v16, 0, v15
    v_lshl_add_u32 v16, v16, 6, v9
    v_xor_b32 v17, 1, v15
    v_lshl_add_u32 v17, v17, 6, v9
    v_xor_b32 v18, 2, v15
    v_lshl_add_u32 v18, v18, 6, v9
    v_xor_b32 v19, 3, v15
    v_lshl_add_u32 v19, v19, 6, v9
    v_and_b32 v15, 1, v0
    v_lshlrev_b32 v15, 9, v15
    v_lshl_add_u32 v11, v2, 3, v15
    v_lshl_add_u32 v15, v2, 4, v15
    v_add_u32 v15, 138752, v15
    s_lshl_b32 s68, s60, 6
    s_add_u32 s68, s68, 139776
    v_add_u32 v11, s68, v11
    s_lshl_b32 s68, s60, 8
    s_add_u32 s68, s68, 138752
    v_add_u32 v13, s68, v63
    s_mov_b32 s72, 0
L_spin44:
    ds_read_b32 v9, v3 offset:56
    s_waitcnt lgkmcnt(0)
    v_readfirstlane_b32 s73, v9
    s_cmp_ge_u32 s73, 4
    s_cbranch_scc1 L_sdone45
    s_add_u32 s72, s72, 1
    s_cmp_lt_u32 s72, 2097152
    s_sleep 2
    s_cbranch_scc1 L_spin44
    s_branch L_sdone45
L_sdone45:
    s_mov_b32 s72, 0
L_qpoll:
    buffer_load_dwordx4 v[20:23], v12, s[36:39], 0 offen sc1
    buffer_load_dwordx4 v[24:27], v61, s[36:39], 0 offen sc1
    s_waitcnt vmcnt(0)
    v_xor_b32 v44, s65, v23
    v_bitop3_b32 v44, v44, v27, s65 bitop3:0xf6
    v_cmp_ne_u32 vcc, 0, v44
    s_cbranch_vccz L_qdone
    s_add_u32 s72, s72, 1
    s_cmp_lt_u32 s72, 262144
    s_sleep 4
    s_cbranch_scc1 L_qpoll
    s_branch L_qdone
L_stub30:
    s_setpc_b64 s[100:101]
L_sk30:
L_qdone:
    v_cmp_ne_u32 vcc, s79, v22
    s_mov_b32 exec_hi, 0
    ds_write_b64 v13, v[20:21]
    s_mov_b32 exec_hi, -1
    s_mov_b32 s68, 0xffff0000
    s_mov_b32 s69, s68
    v_cndmask_b32 v24, v24, v25, s[68:69]
    s_cbranch_vccnz L_mixed
    s_mov_b64 exec, 1
    ds_add_u32 v3, v8 offset:60
    s_mov_b64 exec, -1
L_mixed:
    s_mov_b64 exec, 1
    ds_add_u32 v3, v8 offset:4
    s_mov_b64 exec, -1
    v_mov_b32_dpp v28, v24 quad_perm:[0,0,0,0] row_mask:0xf bank_mask:0xf
    v_mov_b32_dpp v36, v24 quad_perm:[1,1,1,1] row_mask:0xf bank_mask:0xf
    v_lshlrev_b32 v29, 16, v28
    v_and_b32 v30, s68, v28
    v_lshlrev_b32 v37, 16, v36
    v_and_b32 v38, s68, v36
    s_mov_b32 s68, 0x3d372713
    s_mov_b32 s69, 0xc0135761
    v_mul_f32 v31, v29, v29
    v_mul_f32 v31, s68, v31
    v_fma_f32 v31, v31, v29, v29
    v_mul_f32 v31, s69, v31
    v_mul_f32 v32, v30, v30
    v_mul_f32 v32, s68, v32
    v_fma_f32 v32, v32, v30, v30
    v_mul_f32 v32, s69, v32
    v_exp_f32 v31, v31
    v_exp_f32 v32, v32
    s_nop 0
    v_add_f32 v31, 1.0, v31
    v_add_f32 v32, 1.0, v32
    v_rcp_f32 v31, v31
    v_rcp_f32 v32, v32
    s_nop 0
    v_mul_f32 v31, v29, v31
    v_mul_f32 v32, v30, v32
    v_cvt_pk_bf16_f32 v31, v31, v32
    v_lshlrev_b32 v29, 16, v31
    v_and_b32 v30, 0xffff0000, v31
    v_mul_f32 v29, v29, v37
    v_mul_f32 v30, v30, v38
    v_cvt_pk_bf16_f32 v124, v29, v29
    v_cvt_pk_bf16_f32 v125, v30, v30
    s_mov_b32 s72, 0
L_spin46:
    ds_read_b32 v9, v3 offset:4
    s_waitcnt lgkmcnt(0)
    v_readfirstlane_b32 s73, v9
    s_cmp_ge_u32 s73, 4
    s_cbranch_scc1 L_sdone47
    s_add_u32 s72, s72, 1
    s_cmp_lt_u32 s72, 2097152
    s_sleep 1
    s_cbranch_scc1 L_spin46
    s_branch L_sdone47
L_sdone47:
    ds_read_b128 v[128:131], v15 offset:0
    ds_read_b128 v[132:135], v15 offset:64
    ds_read_b128 v[136:139], v15 offset:128
    ds_read_b128 v[140:143], v15 offset:192
    ds_read_b128 v[144:147], v15 offset:256
    ds_read_b128 v[148:151], v15 offset:320
    ds_read_b128 v[152:155], v15 offset:384
    ds_read_b128 v[156:159], v15 offset:448
    s_mov_b32 s76, 0
    v_mov_b32 v60, v3
L_group:
    s_mov_b32 s72, 0
L_spin48:
    ds_read_b32 v9, v60 offset:8
    s_waitcnt lgkmcnt(0)
    v_readfirstlane_b32 s73, v9
    s_cmp_ge_u32 s73, 4
    s_cbranch_scc1 L_sdone49
    s_add_u32 s72, s72, 1
    s_cmp_lt_u32 s72, 2097152
    s_sleep 1
    s_cbranch_scc1 L_spin48
    s_branch L_sdone49
L_sdone49:
    ds_read_b128 v[20:23], v16 offset:0
    ds_read_b128 v[24:27], v17 offset:0
    ds_read_b128 v[28:31], v18 offset:0
    ds_read_b128 v[32:35], v19 offset:0
    ds_read_b128 v[36:39], v16 offset:256
    ds_read_b128 v[40:43], v17 offset:256
    ds_read_b128 v[44:47], v18 offset:256
    ds_read_b128 v[48:51], v19 offset:256
    ds_read_b128 v[64:67], v16 offset:512
    ds_read_b128 v[68:71], v17 offset:512
    ds_read_b128 v[72:75], v18 offset:512
    ds_read_b128 v[76:79], v19 offset:512
    ds_read_b128 v[80:83], v16 offset:768
    ds_read_b128 v[84:87], v17 offset:768
    ds_read_b128 v[88:91], v18 offset:768
    ds_read_b128 v[92:95], v19 offset:768
    s_waitcnt lgkmcnt(15)
    v_mfma_f32_16x16x32_bf16 v[52:55], v[20:23], v[128:131], 0
    s_waitcnt lgkmcnt(14)
    v_mfma_f32_16x16x32_bf16 v[52:55], v[24:27], v[132:135], v[52:55]
    s_waitcnt lgkmcnt(13)
    v_mfma_f32_16x16x32_bf16 v[52:55], v[28:31], v[136:139], v[52:55]
    s_waitcnt lgkmcnt(12)
    v_mfma_f32_16x16x32_bf16 v[52:55], v[32:35], v[140:143], v[52:55]
    s_waitcnt lgkmcnt(11)
    v_mfma_f32_16x16x32_bf16 v[52:55], v[36:39], v[144:147], v[52:55]
    s_waitcnt lgkmcnt(10)
    v_mfma_f32_16x16x32_bf16 v[52:55], v[40:43], v[148:151], v[52:55]
    s_waitcnt lgkmcnt(9)
    v_mfma_f32_16x16x32_bf16 v[52:55], v[44:47], v[152:155], v[52:55]
    s_waitcnt lgkmcnt(8)
    v_mfma_f32_16x16x32_bf16 v[52:55], v[48:51], v[156:159], v[52:55]
    s_waitcnt lgkmcnt(7)
    v_mfma_f32_16x16x32_bf16 v[56:59], v[64:67], v[128:131], 0
    s_waitcnt lgkmcnt(6)
    v_mfma_f32_16x16x32_bf16 v[56:59], v[68:71], v[132:135], v[56:59]
    s_waitcnt lgkmcnt(5)
    v_mfma_f32_16x16x32_bf16 v[56:59], v[72:75], v[136:139], v[56:59]
    s_waitcnt lgkmcnt(4)
    v_mfma_f32_16x16x32_bf16 v[56:59], v[76:79], v[140:143], v[56:59]
    s_waitcnt lgkmcnt(3)
    v_mfma_f32_16x16x32_bf16 v[56:59], v[80:83], v[144:147], v[56:59]
    s_waitcnt lgkmcnt(2)
    v_mfma_f32_16x16x32_bf16 v[56:59], v[84:87], v[148:151], v[56:59]
    s_waitcnt lgkmcnt(1)
    v_mfma_f32_16x16x32_bf16 v[56:59], v[88:91], v[152:155], v[56:59]
    s_waitcnt lgkmcnt(0)
    v_mfma_f32_16x16x32_bf16 v[56:59], v[92:95], v[156:159], v[56:59]
    v_add_u32 v16, 0x10000, v16
    v_add_u32 v17, 0x10000, v17
    v_add_u32 v18, 0x10000, v18
    v_add_u32 v19, 0x10000, v19
    s_mov_b32 exec_lo, 0x00030003
    s_mov_b32 exec_hi, 0x00030003
    s_nop 2
    v_cvt_pk_bf16_f32 v20, v52, v53
    v_cvt_pk_bf16_f32 v21, v54, v55
    ds_write_b64 v11, v[20:21]
    v_cvt_pk_bf16_f32 v22, v56, v57
    v_cvt_pk_bf16_f32 v23, v58, v59
    ds_write_b64 v11, v[22:23] offset:32
    s_mov_b64 exec, 1
    ds_add_rtn_u32 v10, v60, v8 offset:16
    s_mov_b64 exec, -1
    s_waitcnt lgkmcnt(0)
    v_readfirstlane_b32 s73, v10
    s_cmp_eq_u32 s73, 3
    s_cbranch_scc0 L_smdone
    s_branch L_sk34
    .p2align 12
L_stub34:
    s_setpc_b64 s[100:101]
L_sk34:
    s_lshl_b32 s68, s76, 8
    s_add_u32 s68, s68, 139776
    v_lshrrev_b32 v10, 5, v0
    v_lshlrev_b32 v21, 9, v10
    v_lshl_add_u32 v21, v62, 3, v21
    v_add_u32 v22, s68, v21
    v_lshl_add_u32 v10, v10, 4, v3
    ds_read_b64 v[24:25], v22
    ds_read_b64 v[36:37], v10 offset:128
    s_lshl_b32 s68, s76, 9
    s_add_u32 s68, s68, 140800
    v_lshl_add_u32 v21, v21, 1, s68
    s_mov_b32 s68, 0x3db8aa3b
    s_waitcnt lgkmcnt(0)
    v_lshlrev_b32 v26, 16, v24
    v_and_b32 v27, 0xffff0000, v24
    v_lshlrev_b32 v28, 16, v25
    v_and_b32 v29, 0xffff0000, v25
    v_max3_f32 v32, v26, v27, v28
    v_max3_f32 v32, v32, v29, v36
    s_nop 1
    v_max_f32_dpp v32, v32, v32 quad_perm:[1,0,3,2] row_mask:0xf bank_mask:0xf
    s_nop 1
    v_max_f32_dpp v32, v32, v32 quad_perm:[2,3,0,1] row_mask:0xf bank_mask:0xf
    s_nop 1
    v_max_f32_dpp v32, v32, v32 row_half_mirror row_mask:0xf bank_mask:0xf
    s_nop 1
    v_max_f32_dpp v32, v32, v32 row_mirror row_mask:0xf bank_mask:0xf
    v_mov_b32 v33, v32
    s_nop 1
    v_permlane16_swap_b32 v32, v33
    s_nop 0
    v_max_f32 v32, v32, v33
    v_sub_f32 v26, v26, v32
    v_mul_f32 v26, s68, v26
    v_exp_f32 v26, v26
    v_sub_f32 v27, v27, v32
    v_mul_f32 v27, s68, v27
    v_exp_f32 v27, v27
    v_sub_f32 v28, v28, v32
    v_mul_f32 v28, s68, v28
    v_exp_f32 v28, v28
    v_sub_f32 v29, v29, v32
    v_mul_f32 v29, s68, v29
    v_exp_f32 v29, v29
    v_sub_f32 v36, v36, v32
    v_mul_f32 v36, s68, v36
    v_exp_f32 v36, v36
    v_add_f32 v34, v26, v27
    v_add_f32 v35, v28, v29
    v_add_f32 v34, v34, v35
    s_nop 1
    v_add_f32_dpp v34, v34, v34 quad_perm:[1,0,3,2] row_mask:0xf bank_mask:0xf
    s_nop 1
    v_add_f32_dpp v34, v34, v34 quad_perm:[2,3,0,1] row_mask:0xf bank_mask:0xf
    s_nop 1
    v_add_f32_dpp v34, v34, v34 row_half_mirror row_mask:0xf bank_mask:0xf
    s_nop 1
    v_add_f32_dpp v34, v34, v34 row_mirror row_mask:0xf bank_mask:0xf
    v_mov_b32 v35, v34
    s_nop 1
    v_permlane16_swap_b32 v34, v35
    s_nop 0
    v_add_f32 v34, v34, v35
    v_fmac_f32 v34, v36, v37
    v_mov_b32 v33, v34
    s_cmp_eq_u32 s76, 0
    s_cbranch_scc1 L_nonorm
    v_rcp_f32 v38, v34
    v_log_f32 v37, v34
    v_mul_f32 v26, v26, v38
    v_mul_f32 v27, v27, v38
    v_mul_f32 v28, v28, v38
    v_mul_f32 v29, v29, v38
    v_mul_f32 v36, v36, v38
    v_fmac_f32 v37, s68, v32
L_nonorm:
    v_cvt_pk_bf16_f32 v40, v26, v26
    v_cvt_pk_bf16_f32 v41, v27, v27
    v_cvt_pk_bf16_f32 v42, v28, v28
    v_cvt_pk_bf16_f32 v43, v29, v29
    ds_write_b128 v21, v[40:43]
    ds_write_b64 v10, v[32:33] offset:128
    ds_write_b64 v10, v[36:37] offset:136
    s_mov_b64 exec, 1
    ds_add_u32 v60, v8 offset:24
    s_mov_b64 exec, -1
L_smdone:
    s_cmp_eq_u32 s76, 1
    s_cbranch_scc1 L_tail
    v_add_u32 v11, 0x100, v11
    v_add_u32 v60, 4, v60
    s_mov_b32 s76, 1
    s_branch L_group
L_tail:
    s_mul_i32 s68, s61, 34816
    s_add_u32 s68, s68, 69632
    v_bfe_u32 v9, v0, 2, 1
    v_lshlrev_b32 v9, 1, v9
    v_lshl_add_u32 v9, v2, 2, v9
    v_lshl_add_u32 v9, v14, 7, v9
    v_mul_u32_u24 v12, 2176, v9
    v_add_u32 v12, s68, v12
    v_bfe_i32 v9, v0, 2, 1
    v_xor_b32 v9, v9, v0
    v_and_b32 v9, 3, v9
    v_lshl_add_u32 v12, v9, 4, v12
    s_lshl_b32 s68, s67, 8
    s_lshl_b32 s69, s60, 6
    s_add_u32 s68, s68, s69
    v_add_u32 v12, s68, v12
    s_lshl_b32 s78, s66, 3
    s_add_u32 s78, s78, s61
    s_lshl_b32 s78, s78, 3
    s_add_u32 s78, s78, s67
    s_mul_i32 s78, s78, 1152
    s_add_u32 s78, s78, 626688
    v_lshrrev_b32 v13, 1, v2
    v_lshlrev_b32 v13, 9, v13
    v_lshl_add_u32 v13, v1, 5, v13
    v_and_b32 v9, 1, v2
    v_lshl_add_u32 v13, v9, 4, v13
    v_mov_b32 v51, s65
    s_lshl_b32 s68, s60, 10
    s_add_u32 s68, s68, 134656
    v_lshl_add_u32 v62, v0, 4, s68
    v_lshlrev_b32 v63, 4, v0
    v_add_u32 v63, 134656, v63
    s_and_b32 s75, s2, 7
    s_lshl_b32 s75, s75, 1
    s_bfe_u32 s69, s2, 0x10003
    s_or_b32 s75, s75, s69
    s_and_b32 s69, s2, 0x30
    s_or_b32 s75, s75, s69
    s_and_b32 s69, s2, 0xc0
    s_and_b32 s68, s75, 0x34
    s_cmp_eq_u32 s68, 0x34
    s_cselect_b32 s70, 1, 0
    s_or_b32 s70, s70, s69
    s_cmp_lg_u32 s70, 0
    s_cbranch_scc1 L_nored
    s_lshr_b32 s77, s75, 4
    s_mul_i32 s68, s77, 73728
    s_and_b32 s69, s75, 15
    s_lshl_b32 s69, s69, 6
    s_add_u32 s68, s68, s69
    s_add_u32 s68, s68, 626688
    v_lshrrev_b32 v16, 2, v0
    v_mul_u32_u24 v16, 4608, v16
    v_and_b32 v9, 3, v0
    v_lshl_add_u32 v16, v9, 4, v16
    v_add_u32 v16, s68, v16
    s_lshl_b32 s79, s77, 8
    s_and_b32 s68, s75, 7
    s_lshl_b32 s68, s68, 5
    s_add_u32 s79, s79, s68
    s_bfe_u32 s68, s75, 0x10003
    s_mul_i32 s68, s68, 896
    s_add_u32 s79, s79, s68
    v_lshlrev_b32 v17, 3, v9
    v_lshl_add_u32 v17, v2, 1, v17
    s_mov_b64 s[40:41], s[4:5]
    s_mov_b32 s42, 1792
    s_mov_b32 s43, 0x20000
    buffer_load_ushort v56, v17, s[40:43], s79 offen
L_nored:
    s_mov_b64 s[56:57], s[22:23]
    s_mov_b32 s58, 1792
    s_mov_b32 s59, 0x20000
    v_and_b32 v64, v4, v124
    v_and_b32 v65, v5, v124
    v_and_b32 v66, v6, v124
    v_and_b32 v67, v7, v124
    v_and_b32 v68, v4, v125
    v_and_b32 v69, v5, v125
    v_and_b32 v70, v6, v125
    v_and_b32 v71, v7, v125
    s_mov_b32 s72, 0
L_spin50:
    ds_read_b32 v9, v3 offset:80
    s_waitcnt lgkmcnt(0)
    v_readfirstlane_b32 s73, v9
    s_cmp_ge_u32 s73, 4
    s_cbranch_scc1 L_sdone51
    s_add_u32 s72, s72, 1
    s_cmp_lt_u32 s72, 2097152
    s_sleep 1
    s_cbranch_scc1 L_spin50
    s_branch L_sdone51
L_stub37:
    s_setpc_b64 s[100:101]
L_sk37:
L_sdone51:
    s_movk_i32 s69, 7168
    buffer_load_dwordx4 v[112:115], v127, s[52:55], 0 offen offset:0 nt
    buffer_load_dwordx4 v[116:119], v127, s[52:55], 0 offen offset:896 nt
    buffer_load_dwordx4 v[96:99], v126, s[48:51], 0 offen offset:0 nt
    buffer_load_dwordx4 v[100:103], v126, s[48:51], 0 offen offset:3584 nt
    buffer_load_dwordx4 v[104:107], v126, s[48:51], s69 offen offset:0 nt
    buffer_load_dwordx4 v[108:111], v126, s[48:51], s69 offen offset:3584 nt
    s_mov_b32 s44, 0x07060503
    s_mov_b32 s45, 0x07060502
    s_mov_b32 s46, 0x07060501
    s_mov_b32 s48, 0x04000c0c
    s_mov_b32 s49, 0x0706000c
    s_mov_b32 s74, 0xffff0000
    s_mov_b32 s72, 0
L_spin52:
    ds_read_b32 v9, v3 offset:48
    s_waitcnt lgkmcnt(0)
    v_readfirstlane_b32 s73, v9
    s_cmp_ge_u32 s73, 4
    s_cbranch_scc1 L_sdone53
    s_add_u32 s72, s72, 1
    s_cmp_lt_u32 s72, 2097152
    s_sleep 1
    s_cbranch_scc1 L_spin52
    s_branch L_sdone53
L_sdone53:
    s_mov_b32 s72, 0
L_h1poll:
    buffer_load_dwordx4 v[20:23], v12, s[36:39], 0 offen sc1
    buffer_load_dwordx4 v[24:27], v12, s[36:39], 0 offen offset:2176 sc1
    s_waitcnt vmcnt(1)
    v_xor_b32 v44, s65, v23
    s_waitcnt vmcnt(0)
    v_bitop3_b32 v44, v44, v27, s65 bitop3:0xf6
    v_cmp_ne_u32 vcc, 0, v44
    s_cbranch_vccz L_h1done
    s_wqm_b64 exec, vcc
    s_add_u32 s72, s72, 1
    s_cmp_lt_u32 s72, 262144
    s_cbranch_scc1 L_h1poll
L_h1done:
    s_mov_b64 exec, -1
    v_mfma_f32_16x16x32_bf16 v[120:123], v[64:67], v[112:115], 0
    v_mfma_f32_16x16x32_bf16 v[120:123], v[68:71], v[116:119], v[120:123]
    v_max_f32 v45, v22, v26
    v_lshlrev_b32 v28, 16, v20
    v_and_b32 v29, s74, v20
    v_max_f32_dpp v45, v45, v45 row_half_mirror row_mask:0xf bank_mask:0xf
    v_lshlrev_b32 v30, 16, v21
    v_mov_b32 v46, v45
    v_and_b32 v31, s74, v21
    v_lshlrev_b32 v32, 16, v24
    v_permlane16_swap_b32 v45, v46
    v_and_b32 v33, s74, v24
    v_max_f32 v45, v45, v46
    v_mov_b32 v46, v45
    v_lshlrev_b32 v34, 16, v25
    v_and_b32 v35, s74, v25
    v_permlane32_swap_b32 v45, v46
    s_nop 0
    v_max_f32 v45, v45, v46
    v_sub_f32 v22, v22, v45
    v_sub_f32 v26, v26, v45
    v_exp_f32 v22, v22
    v_exp_f32 v26, v26
    v_mul_f32 v28, v22, v28
    v_mul_f32 v30, v22, v30
    v_add_f32 v45, v22, v26
    v_mul_f32 v29, v22, v29
    v_mul_f32 v31, v22, v31
    v_add_f32_dpp v45, v45, v45 row_half_mirror row_mask:0xf bank_mask:0xf
    v_fmac_f32 v28, v26, v32
    v_fmac_f32 v30, v26, v34
    v_mov_b32 v46, v45
    v_fmac_f32 v29, v26, v33
    v_fmac_f32 v31, v26, v35
    v_permlane16_swap_b32 v45, v46
    v_permlane32_swap_b32 v28, v30
    v_add_f32 v45, v45, v46
    v_permlane32_swap_b32 v29, v31
    v_mov_b32 v46, v45
    v_add_f32 v40, v28, v30
    v_add_f32 v41, v29, v31
    v_permlane32_swap_b32 v45, v46
    s_nop 0
    v_permlane16_swap_b32 v40, v41
    v_add_f32 v45, v45, v46
    v_add_f32 v40, v40, v41
    v_rcp_f32 v45, v45
    s_nop 0
    v_add_f32_dpp v40, v40, v40 row_half_mirror row_mask:0xf bank_mask:0xf
    v_mul_f32 v40, v40, v45
    v_cvt_pk_bf16_f32 v40, v40, v40
    s_nop 1
    v_and_b32_dpp v20, v40, v4 quad_perm:[0,0,0,0] row_mask:0xf bank_mask:0xf
    v_and_b32_dpp v21, v40, v5 quad_perm:[0,0,0,0] row_mask:0xf bank_mask:0xf
    v_and_b32_dpp v22, v40, v6 quad_perm:[3,3,3,3] row_mask:0xf bank_mask:0xf
    v_and_b32_dpp v23, v40, v7 quad_perm:[3,3,3,3] row_mask:0xf bank_mask:0xf
    v_and_b32_dpp v24, v40, v4 quad_perm:[1,1,1,1] row_mask:0xf bank_mask:0xf
    v_and_b32_dpp v25, v40, v5 quad_perm:[1,1,1,1] row_mask:0xf bank_mask:0xf
    v_and_b32_dpp v26, v40, v6 quad_perm:[2,2,2,2] row_mask:0xf bank_mask:0xf
    v_and_b32_dpp v27, v40, v7 quad_perm:[2,2,2,2] row_mask:0xf bank_mask:0xf
    v_mfma_f32_16x16x32_bf16 v[120:123], v[20:23], v[96:99], v[120:123]
    v_and_b32_dpp v28, v40, v4 quad_perm:[2,2,2,2] row_mask:0xf bank_mask:0xf
    v_and_b32_dpp v29, v40, v5 quad_perm:[2,2,2,2] row_mask:0xf bank_mask:0xf
    v_and_b32_dpp v30, v40, v6 quad_perm:[1,1,1,1] row_mask:0xf bank_mask:0xf
    v_and_b32_dpp v31, v40, v7 quad_perm:[1,1,1,1] row_mask:0xf bank_mask:0xf
    v_mfma_f32_16x16x32_bf16 v[120:123], v[24:27], v[100:103], v[120:123]
    v_and_b32_dpp v32, v40, v4 quad_perm:[3,3,3,3] row_mask:0xf bank_mask:0xf
    v_and_b32_dpp v33, v40, v5 quad_perm:[3,3,3,3] row_mask:0xf bank_mask:0xf
    v_and_b32_dpp v34, v40, v6 quad_perm:[0,0,0,0] row_mask:0xf bank_mask:0xf
    v_and_b32_dpp v35, v40, v7 quad_perm:[0,0,0,0] row_mask:0xf bank_mask:0xf
    v_mfma_f32_16x16x32_bf16 v[120:123], v[28:31], v[104:107], v[120:123]
    s_nop 1
    v_mfma_f32_16x16x32_bf16 v[120:123], v[32:35], v[108:111], v[120:123]
    s_nop 7
    ds_write_b128 v62, v[120:123]
    s_mov_b64 exec, 1
    ds_add_rtn_u32 v10, v3, v8 offset:52
    s_mov_b64 exec, -1
    ds_read_b128 v[20:23], v63 offset:0
    ds_read_b128 v[24:27], v63 offset:1024
    ds_read_b128 v[28:31], v63 offset:2048
    ds_read_b128 v[32:35], v63 offset:3072
    s_cmp_eq_u32 s66, 3
    s_cselect_b32 exec_lo, 0x00ff00ff, -1
    s_cselect_b32 exec_hi, 0x00ff00ff, -1
    s_waitcnt lgkmcnt(4)
    v_readfirstlane_b32 s73, v10
    s_waitcnt lgkmcnt(2)
    v_pk_add_f32 v[20:21], v[20:21], v[24:25]
    v_pk_add_f32 v[22:23], v[22:23], v[26:27]
    s_cmp_eq_u32 s73, 3
    s_cbranch_scc0 L_fin
    s_waitcnt lgkmcnt(0)
    v_pk_add_f32 v[28:29], v[28:29], v[32:33]
    v_pk_add_f32 v[30:31], v[30:31], v[34:35]
    v_pk_add_f32 v[20:21], v[20:21], v[28:29]
    v_pk_add_f32 v[22:23], v[22:23], v[30:31]
    v_perm_b32 v48, v20, v23, s44
    v_perm_b32 v49, v21, v23, s45
    v_perm_b32 v50, v22, v23, s46
    buffer_store_dwordx4 v[48:51], v13, s[36:39], s78 offen sc1
    s_cmp_lg_u32 s70, 0
    s_cbranch_scc1 L_fin
    s_mov_b64 exec, -1
    v_lshlrev_b32 v57, 16, v56
    s_mov_b32 s72, 0
    s_branch L_sk39
L_stub39:
    s_setpc_b64 s[100:101]
L_sk39:
    s_waitcnt vmcnt(0)
L_upoll:
    buffer_load_dwordx4 v[64:67], v16, s[36:39], 0 offen offset:0 sc1
    buffer_load_dwordx4 v[68:71], v16, s[36:39], 0 offen offset:1152 sc1
    buffer_load_dwordx4 v[72:75], v16, s[36:39], 0 offen offset:2304 sc1
    buffer_load_dwordx4 v[76:79], v16, s[36:39], 0 offen offset:3456 sc1
    s_waitcnt vmcnt(3)
    v_xor_b32 v44, s65, v67
    s_waitcnt vmcnt(2)
    v_bitop3_b32 v44, v44, v71, s65 bitop3:0xf6
    s_waitcnt vmcnt(1)
    v_bitop3_b32 v44, v44, v75, s65 bitop3:0xf6
    s_waitcnt vmcnt(0)
    v_bitop3_b32 v44, v44, v79, s65 bitop3:0xf6
    v_cmp_ne_u32 vcc, 0, v44
    s_cbranch_vccz L_udone
    s_wqm_b64 exec, vcc
    s_add_u32 s72, s72, 1
    s_cmp_lt_u32 s72, 262144
    s_cbranch_scc1 L_upoll
L_udone:
    s_mov_b64 exec, -1
    v_perm_b32 v67, v64, v65, s48
    v_perm_b32 v67, v67, v66, s49
    v_perm_b32 v71, v68, v69, s48
    v_perm_b32 v71, v71, v70, s49
    v_perm_b32 v75, v72, v73, s48
    v_perm_b32 v75, v75, v74, s49
    v_perm_b32 v79, v76, v77, s48
    v_perm_b32 v79, v79, v78, s49
    v_pk_add_f32 v[20:21], v[64:65], v[68:69]
    v_pk_add_f32 v[24:25], v[72:73], v[76:77]
    v_pk_add_f32 v[22:23], v[66:67], v[70:71]
    v_pk_add_f32 v[26:27], v[74:75], v[78:79]
    v_pk_add_f32 v[20:21], v[20:21], v[24:25]
    v_pk_add_f32 v[22:23], v[22:23], v[26:27]
    s_nop 1
    v_permlane32_swap_b32 v20, v22
    v_permlane32_swap_b32 v21, v23
    v_add_f32 v20, v20, v22
    v_add_f32 v21, v21, v23
    s_nop 1
    v_permlane16_swap_b32 v20, v21
    s_nop 0
    v_add_f32 v20, v20, v21
    s_nop 1
    v_add_f32_dpp v20, v20, v20 row_ror:4 row_mask:0xf bank_mask:0xf
    s_nop 1
    v_add_f32_dpp v20, v20, v20 row_ror:8 row_mask:0xf bank_mask:0xf
    v_add_f32 v20, v20, v57
    s_mov_b32 exec_lo, 0x000f000f
    s_mov_b32 exec_hi, 0x000f000f
    v_cvt_pk_bf16_f32 v20, v20, v20
    buffer_store_short v20, v17, s[56:59], s79 offen
    s_cmp_lg_u32 s75, 0
    s_cbranch_scc1 L_fin
    s_mov_b64 exec, 3
    v_mul_u32_u24 v21, 921600, v0
    buffer_store_dword v51, v21, s[36:39], 0 offen
    s_branch L_fin
L_setup:
    s_load_dword s3, s[26:27], 0
    s_load_dword s65, s[26:27], 921600
    v_and_b32 v1, 15, v0
    v_lshrrev_b32 v2, 4, v0
    v_and_b32 v9, 1, v0
    v_lshlrev_b32 v9, 4, v9
    v_mov_b32 v10, 0xffff
    v_lshlrev_b32 v9, v9, v10
    s_mov_b32 s74, 0x3030303
    s_mov_b32 s75, s74
    v_cndmask_b32 v4, 0, v9, s[74:75]
    s_mov_b32 s74, 0xc0c0c0c
    s_mov_b32 s75, s74
    v_cndmask_b32 v5, 0, v9, s[74:75]
    s_mov_b32 s74, 0x30303030
    s_mov_b32 s75, s74
    v_cndmask_b32 v6, 0, v9, s[74:75]
    s_mov_b32 s74, 0xc0c0c0c0
    s_mov_b32 s75, s74
    v_cndmask_b32 v7, 0, v9, s[74:75]
    s_mov_b64 s[36:37], s[26:27]
    s_mov_b32 s38, 921856
    s_mov_b32 s39, 0x20000
    s_lshl_b32 s79, s67, 2
    v_add_u32 v20, s79, v3
    s_lshl_b32 s70, s67, 9
    s_add_u32 s70, s70, 140800
    v_bfe_u32 v14, v0, 3, 1
    v_lshlrev_b32 v14, 10, v14
    v_lshl_add_u32 v14, v2, 7, v14
    v_add_u32 v14, s70, v14
    s_lshl_b32 s70, s76, 11
    s_add_u32 s70, s70, 142848
    v_lshl_add_u32 v15, v0, 5, s70
    s_lshl_b32 s79, s76, 2
    v_add_u32 v16, s79, v3
    s_lshl_b32 s70, s63, 3
    s_add_u32 s70, s70, s61
    s_lshl_b32 s70, s70, 4
    s_add_u32 s70, s70, s64
    s_mul_i32 s70, s70, 2176
    s_lshl_b32 s71, s76, 8
    s_add_u32 s70, s70, s71
    s_add_u32 s70, s70, 69632
    v_lshrrev_b32 v18, 5, v0
    v_lshlrev_b32 v17, 10, v18
    v_and_b32 v9, 7, v0
    v_lshl_add_u32 v17, v9, 5, v17
    v_and_b32 v9, 1, v2
    v_lshl_add_u32 v17, v9, 4, v17
    v_lshl_add_u32 v18, v18, 4, v3
    s_waitcnt lgkmcnt(0)
    s_add_u32 s65, s65, 1
    s_cmp_eq_u32 s65, s3
    s_addc_u32 s65, s65, 0
    v_mov_b32 v63, s65
    s_cmp_eq_u32 s67, 0
    s_cbranch_scc1 L_pwait
    s_mov_b32 s72, 0
L_spin54:
    ds_read_b32 v9, v16 offset:64
    s_waitcnt lgkmcnt(0)
    v_readfirstlane_b32 s73, v9
    s_cmp_ge_u32 s73, 1
    s_cbranch_scc1 L_sdone55
    s_add_u32 s72, s72, 1
    s_cmp_lt_u32 s72, 2097152
    s_sleep 2
    s_cbranch_scc1 L_spin54
    s_branch L_sdone55
L_sdone55:
    s_mov_b32 vcc_lo, s50
    s_mov_b32 vcc_hi, 0
    s_branch L_vissue
L_stream2:
    s_cmp_eq_u32 s67, 0
    s_cbranch_scc1 L_setup
    s_cmp_lg_u32 s77, 0
    s_cbranch_scc1 L_havep
L_pwait:
    s_mov_b32 s72, 0
L_spin56:
    ds_read_b32 v9, v20 offset:24
    s_waitcnt lgkmcnt(0)
    v_readfirstlane_b32 s73, v9
    s_cmp_ge_u32 s73, 1
    s_cbranch_scc1 L_sdone57
    s_add_u32 s72, s72, 1
    s_cmp_lt_u32 s72, 2097152
    s_sleep 1
    s_cbranch_scc1 L_spin56
    s_branch L_sdone57
L_sdone57:
    ds_read_b128 v[128:131], v14 offset:0
    ds_read_b128 v[132:135], v14 offset:16
    ds_read_b128 v[136:139], v14 offset:32
    ds_read_b128 v[140:143], v14 offset:48
    ds_read_b128 v[144:147], v14 offset:64
    ds_read_b128 v[148:151], v14 offset:80
    ds_read_b128 v[152:155], v14 offset:96
    ds_read_b128 v[156:159], v14 offset:112
L_havep:
    s_waitcnt lgkmcnt(0)
    v_and_b32 v24, v4, v128
    v_and_b32 v25, v5, v128
    v_and_b32 v26, v6, v128
    v_and_b32 v27, v7, v128
    v_and_b32 v28, v4, v144
    v_and_b32 v29, v5, v144
    v_and_b32 v30, v6, v144
    v_and_b32 v31, v7, v144
    s_waitcnt vmcnt(15)
    v_mfma_f32_16x16x32_bf16 v[48:51], v[24:27], v[64:67], 0
    v_and_b32 v24, v4, v129
    v_and_b32 v25, v5, v129
    v_and_b32 v26, v6, v129
    v_and_b32 v27, v7, v129
    v_mfma_f32_16x16x32_bf16 v[52:55], v[28:31], v[64:67], 0
    v_and_b32 v28, v4, v145
    v_and_b32 v29, v5, v145
    v_and_b32 v30, v6, v145
    v_and_b32 v31, v7, v145
    s_waitcnt vmcnt(14)
    v_mfma_f32_16x16x32_bf16 v[48:51], v[24:27], v[68:71], v[48:51]
    v_and_b32 v24, v4, v130
    v_and_b32 v25, v5, v130
    v_and_b32 v26, v6, v130
    v_and_b32 v27, v7, v130
    v_mfma_f32_16x16x32_bf16 v[52:55], v[28:31], v[68:71], v[52:55]
    v_and_b32 v28, v4, v146
    v_and_b32 v29, v5, v146
    v_and_b32 v30, v6, v146
    v_and_b32 v31, v7, v146
    s_branch L_sk45
L_stub45:
    s_setpc_b64 s[100:101]
L_sk45:
    s_waitcnt vmcnt(13)
    v_mfma_f32_16x16x32_bf16 v[48:51], v[24:27], v[72:75], v[48:51]
    v_and_b32 v24, v4, v131
    v_and_b32 v25, v5, v131
    v_and_b32 v26, v6, v131
    v_and_b32 v27, v7, v131
    v_mfma_f32_16x16x32_bf16 v[52:55], v[28:31], v[72:75], v[52:55]
    v_and_b32 v28, v4, v147
    v_and_b32 v29, v5, v147
    v_and_b32 v30, v6, v147
    v_and_b32 v31, v7, v147
    s_waitcnt vmcnt(12)
    v_mfma_f32_16x16x32_bf16 v[48:51], v[24:27], v[76:79], v[48:51]
    v_and_b32 v24, v4, v132
    v_and_b32 v25, v5, v132
    v_and_b32 v26, v6, v132
    v_and_b32 v27, v7, v132
    v_mfma_f32_16x16x32_bf16 v[52:55], v[28:31], v[76:79], v[52:55]
    v_and_b32 v28, v4, v148
    v_and_b32 v29, v5, v148
    v_and_b32 v30, v6, v148
    v_and_b32 v31, v7, v148
    s_waitcnt vmcnt(11)
    v_mfma_f32_16x16x32_bf16 v[48:51], v[24:27], v[80:83], v[48:51]
    v_and_b32 v24, v4, v133
    v_and_b32 v25, v5, v133
    v_and_b32 v26, v6, v133
    v_and_b32 v27, v7, v133
    v_mfma_f32_16x16x32_bf16 v[52:55], v[28:31], v[80:83], v[52:55]
    v_and_b32 v28, v4, v149
    v_and_b32 v29, v5, v149
    v_and_b32 v30, v6, v149
    v_and_b32 v31, v7, v149
    s_waitcnt vmcnt(10)
    v_mfma_f32_16x16x32_bf16 v[48:51], v[24:27], v[84:87], v[48:51]
    v_and_b32 v24, v4, v134
    v_and_b32 v25, v5, v134
    v_and_b32 v26, v6, v134
    v_and_b32 v27, v7, v134
    v_mfma_f32_16x16x32_bf16 v[52:55], v[28:31], v[84:87], v[52:55]
    v_and_b32 v28, v4, v150
    v_and_b32 v29, v5, v150
    v_and_b32 v30, v6, v150
    v_and_b32 v31, v7, v150
    s_waitcnt vmcnt(9)
    v_mfma_f32_16x16x32_bf16 v[48:51], v[24:27], v[88:91], v[48:51]
    v_and_b32 v24, v4, v135
    v_and_b32 v25, v5, v135
    v_and_b32 v26, v6, v135
    v_and_b32 v27, v7, v135
    v_mfma_f32_16x16x32_bf16 v[52:55], v[28:31], v[88:91], v[52:55]
    v_and_b32 v28, v4, v151
    v_and_b32 v29, v5, v151
    v_and_b32 v30, v6, v151
    v_and_b32 v31, v7, v151
    s_waitcnt vmcnt(8)
    v_mfma_f32_16x16x32_bf16 v[48:51], v[24:27], v[92:95], v[48:51]
    v_and_b32 v24, v4, v136
    v_and_b32 v25, v5, v136
    v_and_b32 v26, v6, v136
    v_and_b32 v27, v7, v136
    v_mfma_f32_16x16x32_bf16 v[52:55], v[28:31], v[92:95], v[52:55]
    v_and_b32 v28, v4, v152
    v_and_b32 v29, v5, v152
    v_and_b32 v30, v6, v152
    v_and_b32 v31, v7, v152
    s_cmp_eq_u32 s67, 0
    s_cbranch_scc1 L_noold
    s_cmp_lg_u32 s77, 0
    s_cbranch_scc1 L_haveold
    s_mov_b32 s72, 0
L_spin58:
    ds_read_b32 v9, v16 offset:32
    s_waitcnt lgkmcnt(0)
    v_readfirstlane_b32 s73, v9
    s_cmp_ge_u32 s73, 1
    s_cbranch_scc1 L_sdone59
    s_add_u32 s72, s72, 1
    s_cmp_lt_u32 s72, 2097152
    s_sleep 1
    s_cbranch_scc1 L_spin58
    s_branch L_sdone59
L_sdone59:
    ds_read_b128 v[32:35], v15
    ds_read_b128 v[36:39], v15 offset:16
    ds_read_b64 v[40:41], v18 offset:136
    ds_read_b32 v42, v3 offset:60
    s_waitcnt lgkmcnt(0)
L_haveold:
    s_nop 1
    v_readfirstlane_b32 s78, v42
    v_mov_b32 v62, v41
    v_fmac_f32 v48, v32, v40
    v_fmac_f32 v49, v33, v40
    v_fmac_f32 v50, v34, v40
    v_fmac_f32 v51, v35, v40
    v_fmac_f32 v52, v36, v40
    v_fmac_f32 v53, v37, v40
    v_fmac_f32 v54, v38, v40
    v_fmac_f32 v55, v39, v40
    s_nop 0
L_noold:
    s_waitcnt vmcnt(7)
    v_mfma_f32_16x16x32_bf16 v[48:51], v[24:27], v[96:99], v[48:51]
    v_and_b32 v24, v4, v137
    v_and_b32 v25, v5, v137
    v_and_b32 v26, v6, v137
    v_and_b32 v27, v7, v137
    v_mfma_f32_16x16x32_bf16 v[52:55], v[28:31], v[96:99], v[52:55]
    v_and_b32 v28, v4, v153
    v_and_b32 v29, v5, v153
    v_and_b32 v30, v6, v153
    v_and_b32 v31, v7, v153
    s_waitcnt vmcnt(6)
    v_mfma_f32_16x16x32_bf16 v[48:51], v[24:27], v[100:103], v[48:51]
    v_and_b32 v24, v4, v138
    v_and_b32 v25, v5, v138
    v_and_b32 v26, v6, v138
    v_and_b32 v27, v7, v138
    v_mfma_f32_16x16x32_bf16 v[52:55], v[28:31], v[100:103], v[52:55]
    v_and_b32 v28, v4, v154
    v_and_b32 v29, v5, v154
    v_and_b32 v30, v6, v154
    v_and_b32 v31, v7, v154
    s_waitcnt vmcnt(5)
    v_mfma_f32_16x16x32_bf16 v[48:51], v[24:27], v[104:107], v[48:51]
    v_and_b32 v24, v4, v139
    v_and_b32 v25, v5, v139
    v_and_b32 v26, v6, v139
    v_and_b32 v27, v7, v139
    v_mfma_f32_16x16x32_bf16 v[52:55], v[28:31], v[104:107], v[52:55]
    v_and_b32 v28, v4, v155
    v_and_b32 v29, v5, v155
    v_and_b32 v30, v6, v155
    v_and_b32 v31, v7, v155
    s_waitcnt vmcnt(4)
    v_mfma_f32_16x16x32_bf16 v[48:51], v[24:27], v[108:111], v[48:51]
    v_and_b32 v24, v4, v140
    v_and_b32 v25, v5, v140
    v_and_b32 v26, v6, v140
    v_and_b32 v27, v7, v140
    v_mfma_f32_16x16x32_bf16 v[52:55], v[28:31], v[108:111], v[52:55]
    v_and_b32 v28, v4, v156
    v_and_b32 v29, v5, v156
    v_and_b32 v30, v6, v156
    v_and_b32 v31, v7, v156
    s_waitcnt vmcnt(3)
    v_mfma_f32_16x16x32_bf16 v[48:51], v[24:27], v[112:115], v[48:51]
    v_and_b32 v24, v4, v141
    v_and_b32 v25, v5, v141
    v_and_b32 v26, v6, v141
    v_and_b32 v27, v7, v141
    v_mfma_f32_16x16x32_bf16 v[52:55], v[28:31], v[112:115], v[52:55]
    v_and_b32 v28, v4, v157
    v_and_b32 v29, v5, v157
    v_and_b32 v30, v6, v157
    v_and_b32 v31, v7, v157
    s_waitcnt vmcnt(2)
    v_mfma_f32_16x16x32_bf16 v[48:51], v[24:27], v[116:119], v[48:51]
    v_and_b32 v24, v4, v142
    v_and_b32 v25, v5, v142
    v_and_b32 v26, v6, v142
    v_and_b32 v27, v7, v142
    v_mfma_f32_16x16x32_bf16 v[52:55], v[28:31], v[116:119], v[52:55]
    v_and_b32 v28, v4, v158
    v_and_b32 v29, v5, v158
    v_and_b32 v30, v6, v158
    v_and_b32 v31, v7, v158
    s_waitcnt vmcnt(1)
    v_mfma_f32_16x16x32_bf16 v[48:51], v[24:27], v[120:123], v[48:51]
    v_and_b32 v24, v4, v143
    v_and_b32 v25, v5, v143
    v_and_b32 v26, v6, v143
    v_and_b32 v27, v7, v143
    v_mfma_f32_16x16x32_bf16 v[52:55], v[28:31], v[120:123], v[52:55]
    v_and_b32 v28, v4, v159
    v_and_b32 v29, v5, v159
    v_and_b32 v30, v6, v159
    v_and_b32 v31, v7, v159
    s_waitcnt vmcnt(0)
    v_mfma_f32_16x16x32_bf16 v[48:51], v[24:27], v[124:127], v[48:51]
    v_mfma_f32_16x16x32_bf16 v[52:55], v[28:31], v[124:127], v[52:55]
    s_cmp_eq_u32 s67, 0
    s_cbranch_scc1 L_old
    s_nop 5
    v_add_f32_dpp v56, v52, v48 row_ror:8 row_mask:0xf bank_mask:0xf
    v_add_f32_dpp v57, v53, v49 row_ror:8 row_mask:0xf bank_mask:0xf
    v_add_f32_dpp v58, v54, v50 row_ror:8 row_mask:0xf bank_mask:0xf
    v_add_f32_dpp v59, v55, v51 row_ror:8 row_mask:0xf bank_mask:0xf
    s_mov_b32 exec_lo, 0x00ff00ff
    s_mov_b32 exec_hi, 0x00ff00ff
    v_cvt_pk_bf16_f32 v60, v56, v57
    v_cvt_pk_bf16_f32 v61, v58, v59
    s_cmp_lg_u32 s78, 4
    s_cbranch_scc1 L_slow60
    buffer_store_dwordx4 v[60:63], v17, s[36:39], s70 offen
    s_branch L_stdone61
L_slow60:
    buffer_store_dwordx4 v[60:63], v17, s[36:39], s70 offen sc1
L_stdone61:
    s_mov_b64 exec, 1
    ds_add_u32 v3, v8 offset:48
    s_mov_b64 exec, -1
    s_branch L_fin
L_old:
    s_nop 6
    ds_write_b128 v15, v[48:51]
    ds_write_b128 v15, v[52:55] offset:16
    s_mov_b64 exec, 1
    ds_add_u32 v16, v8 offset:32
    s_mov_b64 exec, -1
L_fin:
L_end:
    s_endpgm
.section .rodata,"a"
.p2align 6
.amdhsa_kernel parallel_sum__sliding_block_cached__glu_gated_geglu__decode_kernel
  .amdhsa_next_free_vgpr 160
  .amdhsa_next_free_sgpr 102
  .amdhsa_accum_offset 160
  .amdhsa_group_segment_fixed_size 0
  .amdhsa_kernarg_size 96
  .amdhsa_user_sgpr_count 2
  .amdhsa_user_sgpr_kernarg_segment_ptr 1
  .amdhsa_system_sgpr_workgroup_id_x 1
  .amdhsa_float_denorm_mode_32 3
.end_amdhsa_kernel
```
